```python
import torch

def _softmax(x, axis=-1):
    return torch.softmax(x, dim=axis)

def _gelu(x):
    return torch.nn.functional.gelu(x, approximate='tanh')

def _silu(x):
    return torch.nn.functional.silu(x)

def _sigmoid(x):
    return torch.sigmoid(x)

def _layernorm(x, axis=-1, eps=1e-05):
    m = x.mean(dim=axis, keepdim=True)
    v = x.var(dim=axis, keepdim=True, unbiased=False)
    return (x - m) / torch.sqrt(v + eps)

def _scatter_add(tgt, idx, src, axis=0):
    return tgt.clone().index_add_(axis, idx, src)

def _segment_sum(src, seg, n):
    out = torch.zeros((n,) + src.shape[1:], dtype=src.dtype)
    return out.index_add_(0, seg, src)

def _pad(x, pw):
    flat = tuple((v for pair in reversed(pw) for v in pair))
    return torch.nn.functional.pad(x, flat)
kernel_name = 'adaLN_cond__gqa_block_cached__glu_gated_bilinear__decode'

def setup_inputs():

    _w = lambda a: (lambda t: t.to(torch.bfloat16) if t.is_floating_point() else t)(torch.as_tensor(a))

    def _A_setup():
        B, Sq, D = (4, 1, 640)
        Hq, Hkv, Sk, Dh = (32, 32, 4096, 192)
        assert Hq % Hkv == 0, (Hq, Hkv)
        return {'x': _w((lambda *s: torch.randn(*s, dtype=torch.bfloat16) * 0.1)(B, Sq, D)), 'k_cache': _w((lambda *s: torch.randn(*s, dtype=torch.bfloat16) * 0.8)(B, Hkv, Sk, Dh)), 'v_cache': _w((lambda *s: torch.randn(*s, dtype=torch.bfloat16) * 3.2)(B, Hkv, Sk, Dh)), 'wq': _w((lambda *s: torch.randn(*s, dtype=torch.bfloat16) * 0.8)(D, Hq * Dh) * D ** (-0.5)), 'wo': _w((lambda *s: torch.randn(*s, dtype=torch.bfloat16) * 3.2)(Hq * Dh, D) * (Hq * Dh) ** (-0.5))}
    _A_in = _A_setup()

    def _B_setup():
        B, S, D, F = (4, 1, 640, 1536)
        return {'x': _w((lambda *s: torch.randn(*s, dtype=torch.bfloat16) * 0.1)(B, S, D)), 'w_gate': _w((lambda *s: torch.randn(*s, dtype=torch.bfloat16) * 3.2)(D, F) * D ** (-0.5)), 'w_up': _w((lambda *s: torch.randn(*s, dtype=torch.bfloat16) * 3.2)(D, F) * D ** (-0.5)), 'w_down': _w((lambda *s: torch.randn(*s, dtype=torch.bfloat16) * 3.2)(F, D) * F ** (-0.5))}
    _B_in = _B_setup()
    return {'A_x': _A_in['x'], 'A_k_cache': _A_in['k_cache'], 'A_v_cache': _A_in['v_cache'], 'A_wq': _A_in['wq'], 'A_wo': _A_in['wo'], 'B_x': _B_in['x'], 'B_w_gate': _B_in['w_gate'], 'B_w_up': _B_in['w_up'], 'B_w_down': _B_in['w_down'], 'c': _w((lambda *s: torch.randn(*s, dtype=torch.bfloat16) * 0.4)(4, 640) * 8.0), 'w_mod': _w((lambda *s: torch.randn(*s, dtype=torch.bfloat16) * 0.4)(640, 6 * 640) * 640 ** (-0.5) * 8.0)}

def reference(A_x, A_k_cache, A_v_cache, A_wq, A_wo, B_x, B_w_gate, B_w_up, B_w_down, c, w_mod):

    def _A_ref(x, k_cache, v_cache, wq, wo):
        B, Sq, D = x.shape
        Hq, Dh = (32, 192)
        Hkv = k_cache.shape[1]
        rep = Hq // Hkv
        q = (lambda x, *d: x.permute(*d))((x @ wq).reshape(B, Sq, Hq, Dh), 0, 2, 1, 3)
        k = (lambda x, n, axis: torch.repeat_interleave(x, n, dim=axis))(k_cache, rep, axis=1)
        v = (lambda x, n, axis: torch.repeat_interleave(x, n, dim=axis))(v_cache, rep, axis=1)
        scores = torch.einsum('bhqd,bhkd->bhqk', q, k) * Dh ** (-0.5)
        p = _softmax(scores, axis=-1)
        o = torch.einsum('bhqk,bhkd->bhqd', p, v)
        return (lambda x, *d: x.permute(*d))(o, 0, 2, 1, 3).reshape(B, Sq, Hq * Dh) @ wo

    def _B_ref(x, w_gate, w_up, w_down):
        g = torch.einsum('bsd,df->bsf', x, w_gate)
        u = torch.einsum('bsd,df->bsf', x, w_up)
        h = g * u
        return torch.einsum('bsf,fd->bsd', h, w_down)
    x = A_x
    mod = (_silu(c) @ w_mod).reshape(c.shape[0], 6, 1, -1)
    sa, ca, ga, sb, cb, gb = (mod[:, 0].clone(), mod[:, 1].clone(), mod[:, 2].clone(), mod[:, 3].clone(), mod[:, 4].clone(), mod[:, 5].clone())
    h = _layernorm(x, axis=-1) * (1 + ca) + sa
    x = x + ga * _A_ref(h, A_k_cache, A_v_cache, A_wq, A_wo)
    h = _layernorm(x, axis=-1) * (1 + cb) + sb
    x = x + gb * _B_ref(h, B_w_gate, B_w_up, B_w_down)
    return x
```

```asm
; @launch grid=(256,1,1) block=(512,1,1) lds=163840
.amdgcn_target "amdgcn-amd-amdhsa--gfx950"
.text
.globl adaLN_cond__gqa_block_cached__glu_gated_bilinear__decode_kernel
.p2align 8
.type adaLN_cond__gqa_block_cached__glu_gated_bilinear__decode_kernel,@function
adaLN_cond__gqa_block_cached__glu_gated_bilinear__decode_kernel:
    s_cmp_ge_u32 s2, 256
    s_cbranch_scc1 Lexit
    s_load_dwordx16 s[4:19], s[0:1], 0
    s_load_dwordx8 s[20:27], s[0:1], 64
    s_load_dwordx4 s[28:31], s[0:1], 96
    v_lshrrev_b32 v2, 6, v0
    v_and_b32 v1, 63, v0
    s_nop 0
    v_readfirstlane_b32 s33, v2
    s_lshr_b32 s34, s2, 3
    s_and_b32 s35, s2, 7
    s_mov_b32 s96, 400000
    s_mov_b32 s97, 0x05040100
    s_mov_b32 s98, 0x07060302
    s_cmp_ge_u32 s33, 4
    s_cbranch_scc1 Lhelper
    v_add_u32 v13, 0, v1
    v_mul_u32_u24 v14, 2731, v13
    v_lshrrev_b32 v14, 16, v14
    v_mul_u32_u24 v15, 24, v14
    v_sub_u32 v15, v13, v15
    v_and_b32 v16, 7, v14
    v_xor_b32 v15, v15, v16
    v_mul_u32_u24 v14, 384, v14
    v_lshl_add_u32 v2, v15, 4, v14
    v_add_u32 v13, 64, v1
    v_mul_u32_u24 v14, 2731, v13
    v_lshrrev_b32 v14, 16, v14
    v_mul_u32_u24 v15, 24, v14
    v_sub_u32 v15, v13, v15
    v_and_b32 v16, 7, v14
    v_xor_b32 v15, v15, v16
    v_mul_u32_u24 v14, 384, v14
    v_lshl_add_u32 v3, v15, 4, v14
    v_subrev_u32 v3, 1024, v3
    v_add_u32 v13, 128, v1
    v_mul_u32_u24 v14, 2731, v13
    v_lshrrev_b32 v14, 16, v14
    v_mul_u32_u24 v15, 24, v14
    v_sub_u32 v15, v13, v15
    v_and_b32 v16, 7, v14
    v_xor_b32 v15, v15, v16
    v_mul_u32_u24 v14, 384, v14
    v_lshl_add_u32 v4, v15, 4, v14
    v_subrev_u32 v4, 2048, v4
    v_and_b32 v13, 15, v1
    v_lshrrev_b32 v14, 4, v1
    v_and_b32 v15, 7, v13
    v_mul_u32_u24 v13, 384, v13
    v_add_u32 v16, 0, v14
    v_xor_b32 v16, v16, v15
    v_lshl_add_u32 v5, v16, 4, v13
    v_add_u32 v16, 4, v14
    v_xor_b32 v16, v16, v15
    v_lshl_add_u32 v6, v16, 4, v13
    v_lshrrev_b32 v13, 2, v1
    v_and_b32 v15, 7, v13
    v_mul_u32_u24 v13, 384, v13
    v_and_b32 v16, 1, v1
    v_lshl_add_u32 v13, v16, 3, v13
    v_bfe_u32 v16, v1, 1, 1
    v_add_u32 v17, 0, v16
    v_xor_b32 v17, v17, v15
    v_lshl_add_u32 v7, v17, 4, v13
    v_add_u32 v17, 2, v16
    v_xor_b32 v17, v17, v15
    v_lshl_add_u32 v8, v17, 4, v13
    v_add_u32 v17, 4, v16
    v_xor_b32 v17, v17, v15
    v_lshl_add_u32 v9, v17, 4, v13
    v_add_u32 v17, 6, v16
    v_xor_b32 v17, v17, v15
    v_lshl_add_u32 v10, v17, 4, v13
    v_lshlrev_b32 v13, 4, v14
    s_lshl_b32 s62, s33, 8
    s_add_u32 s62, s62, 154624
    v_add_u32 v12, s62, v13
    s_lshl_b32 s62, s33, 10
    s_add_u32 s62, s62, 147456
    v_add_u32 v180, s62, v13
    v_add_u32 v181, 160768, v13
    s_mul_i32 s62, s33, 768
    s_add_u32 s62, s62, 151552
    v_and_b32 v15, 15, v1
    v_lshlrev_b32 v15, 2, v15
    v_add_u32 v182, s62, v15
    v_mul_u32_u24 v15, 12, v1
    v_add_u32 v183, 151552, v15
    s_lshl_b32 s63, s33, 2
    s_add_u32 s63, s63, 162432
    v_mov_b32 v18, s63
    v_mov_b32 v19, 1
    v_mov_b32 v178, 162432
    s_mul_i32 s61, s34, 1572864
    s_lshl_b32 s94, s33, 4
    s_add_u32 s50, s94, 162752
    s_add_u32 s94, s94, 162688
    s_lshl_b32 s48, s35, 2
    s_add_u32 s48, s48, s33
    s_mul_i32 s49, s34, 32
    s_mov_b32 s64, 0
    s_mov_b32 s51, 0
    s_mov_b32 s53, 0
    s_mov_b32 s52, 0
    s_mul_i32 s55, s33, 36864
    s_mov_b32 s54, s55
    s_add_u32 s56, s55, 36864
    s_mov_b32 s58, s55
    s_mov_b32 s60, 0
    s_mov_b32 s65, 0
    s_mov_b32 s69, 0
    s_mov_b32 s57, 0
    s_mov_b32 s71, 0
    s_waitcnt lgkmcnt(0)
    s_mov_b32 s40, s30
    s_and_b32 s41, s31, 0xffff
    s_mov_b32 s42, 8388608
    s_mov_b32 s43, 0x20000
    s_load_dword s32, s[30:31], 0
    s_and_b32 s92, s7, 0xffff
    s_and_b32 s93, s9, 0xffff
    s_mov_b32 s36, s6
    s_and_b32 s37, s7, 0xffff
    s_mov_b32 s38, 201326592
    s_mov_b32 s39, 0x20000
    s_barrier
Lf0_1:
    s_cmp_lt_u32 s52, 7
    s_cbranch_scc0 Lf0d_2
    s_and_b32 s62, s52, 3
    s_cbranch_scc1 Lim_3
    s_lshr_b32 s62, s52, 2
    s_cmp_lt_u32 s62, 29
    s_cbranch_scc0 Liy_6
    s_and_b32 s63, s62, 0
    s_cbranch_scc1 Lal_9
    s_cmp_eq_u32 s62, 0
    s_cbranch_scc1 Lal_9
    s_add_u32 s51, s51, 4
    s_sub_u32 s66, s51, 1
    s_mov_b64 exec, 1
    ds_add_u32 v178, v19 offset:28
    s_mov_b64 exec, -1
Lw_10:
    ds_read_b32 v13, v178 offset:28
    s_waitcnt lgkmcnt(0)
    v_readfirstlane_b32 s90, v13
    s_nop 0
    s_cmp_gt_u32 s90, s66
    s_cbranch_scc1 Lwd_11
    s_sub_u32 s96, s96, 1
    s_cbranch_scc1 Labort
    s_branch Lw_10
Lwd_11:
    s_lshr_b32 s62, s52, 2
Lal_9:
    s_and_b32 s63, s62, 3
    s_lshl_b32 s63, s63, 5
    s_add_u32 s71, s63, s48
    s_bfe_u32 s63, s62, 0x20002
    s_cmp_lt_u32 s62, 16
    s_cselect_b32 s36, s6, s8
    s_cselect_b32 s37, s92, s93
    s_branch Lih_7
Liy_6:
    s_and_b32 s63, s64, 3
    s_lshl_b32 s63, s63, 2
    s_add_u32 s63, s63, s50
    v_mov_b32 v21, s63
Lw_12:
    ds_read_b32 v22, v18 offset:112
    s_waitcnt lgkmcnt(0)
    v_readfirstlane_b32 s90, v22
    s_nop 0
    s_cmp_gt_u32 s90, s64
    s_cbranch_scc1 Lwd_13
    s_sleep 1
    s_sub_u32 s96, s96, 1
    s_cbranch_scc1 Labort
    s_branch Lw_12
Lwd_13:
    ds_read_b32 v13, v21
    s_waitcnt lgkmcnt(0)
    v_readfirstlane_b32 s71, v13
    s_add_u32 s64, s64, 1
    s_cmp_ge_u32 s71, 96
    s_cbranch_scc1 Lis_4
    s_add_u32 s71, s71, 32
    s_mov_b32 s63, 3
    s_lshr_b32 s62, s52, 2
Lih_7:
    s_mul_i32 s63, s63, 50331648
    s_add_u32 s53, s61, s63
    s_add_u32 s63, s71, s49
    s_and_b32 s63, s63, 127
    s_mul_i32 s63, s63, 12288
    s_add_u32 s53, s53, s63
    s_cmp_ge_u32 s62, 28
    s_cbranch_scc0 Lim_3
    s_and_b32 s62, s65, 3
    s_lshl_b32 s62, s62, 2
    s_add_u32 s62, s62, s94
    v_mov_b32 v13, s62
    v_mov_b32 v21, s71
    s_add_u32 s65, s65, 1
    v_mov_b32 v22, s65
    s_mov_b64 exec, 1
    ds_write_b32 v13, v21
    ds_write_b32 v18, v22 offset:80
    s_mov_b64 exec, -1
Lim_3:
    s_cmp_lt_u32 s52, 116
    s_cbranch_scc1 Ln1_14
    s_waitcnt vmcnt(9)
    s_branch Ln2_15
Ln1_14:
    s_waitcnt vmcnt(5)
Ln2_15:
    s_mov_b32 m0, s54
    s_add_u32 s54, s54, 3072
    buffer_load_dwordx4 v2, s[36:39], s53 offen nt lds
    s_cmp_lt_u32 s52, 116
    s_cbranch_scc0 Lpw_16
    s_waitcnt vmcnt(5)
Lpw_16:
    buffer_load_dwordx4 v3, s[36:39], s53 offen offset:1024 nt lds
    s_cmp_lt_u32 s52, 116
    s_cbranch_scc0 Lpw_17
    s_waitcnt vmcnt(5)
Lpw_17:
    buffer_load_dwordx4 v4, s[36:39], s53 offen offset:2048 nt lds
    s_cmp_eq_u32 s54, s56
    s_cselect_b32 s54, s55, s54
    s_add_u32 s53, s53, 3072
    s_add_u32 s52, s52, 1
    s_branch Lid_5
Lis_4:
    s_mov_b32 s60, 1
    s_and_b32 s62, s65, 3
    s_lshl_b32 s62, s62, 2
    s_add_u32 s62, s62, s94
    v_mov_b32 v13, s62
    v_mov_b32 v21, 0xffff
    s_add_u32 s65, s65, 1
    v_mov_b32 v22, s65
    s_mov_b64 exec, 1
    ds_write_b32 v13, v21
    ds_write_b32 v18, v22 offset:80
    s_mov_b64 exec, -1
Lid_5:
    s_branch Lf0_1
Lf0d_2:
    v_add_u32 v14, s58, v5
    v_add_u32 v15, s58, v6
    ds_read_b128 v[48:51], v14 offset:0
    ds_read_b128 v[52:55], v14 offset:6144
    ds_read_b128 v[56:59], v15 offset:0
    ds_read_b128 v[60:63], v15 offset:6144
    ds_read_b128 v[64:67], v14 offset:128
    ds_read_b128 v[68:71], v14 offset:6272
    ds_read_b128 v[72:75], v15 offset:128
    ds_read_b128 v[76:79], v15 offset:6272
    ds_read_b128 v[80:83], v14 offset:256
    ds_read_b128 v[84:87], v14 offset:6400
    ds_read_b128 v[88:91], v15 offset:256
    ds_read_b128 v[92:95], v15 offset:6400
    v_mov_b32 v104, 0
    v_mov_b32 v105, 0
    v_mov_b32 v106, 0
    v_mov_b32 v107, 0
    v_mov_b32 v108, 0
    v_mov_b32 v109, 0
    v_mov_b32 v110, 0
    v_mov_b32 v111, 0
    v_mov_b32 v112, 0
    v_mov_b32 v113, 0
    v_mov_b32 v114, 0
    v_mov_b32 v115, 0
    v_mov_b32 v116, 0
    v_mov_b32 v117, 0
    v_mov_b32 v118, 0
    v_mov_b32 v119, 0
    v_mov_b32 v120, 0
    v_mov_b32 v121, 0
    v_mov_b32 v122, 0
    v_mov_b32 v123, 0
    v_mov_b32 v124, 0
    v_mov_b32 v125, 0
    v_mov_b32 v126, 0
    v_mov_b32 v127, 0
    v_mov_b32 v128, 0
    v_mov_b32 v129, 0
    v_mov_b32 v130, 0
    v_mov_b32 v131, 0
    v_mov_b32 v132, 0
    v_mov_b32 v133, 0
    v_mov_b32 v134, 0
    v_mov_b32 v135, 0
    v_mov_b32 v136, 0
    v_mov_b32 v137, 0
    v_mov_b32 v138, 0
    v_mov_b32 v139, 0
    v_mov_b32 v140, 0
    v_mov_b32 v141, 0
    v_mov_b32 v142, 0
    v_mov_b32 v143, 0
    v_mov_b32 v144, 0
    v_mov_b32 v145, 0
    v_mov_b32 v146, 0
    v_mov_b32 v147, 0
    v_mov_b32 v148, 0
    v_mov_b32 v149, 0
    v_mov_b32 v150, 0
    v_mov_b32 v151, 0
Lf_18:
    ds_read_b64 v[14:15], v178 offset:16
    ds_read_b32 v16, v178 offset:8
    s_waitcnt lgkmcnt(0)
    v_readfirstlane_b32 s90, v14
    v_readfirstlane_b32 s62, v15
    v_readfirstlane_b32 s63, v16
    s_nop 0
    s_lshl_b32 s63, s63, 2
    s_and_b32 s63, s63, s90
    s_cmp_eq_u32 s63, 4
    s_cbranch_scc1 Lfd_19
    s_cmp_eq_u32 s62, 0
    s_cbranch_scc0 Lfn_20
    s_cmp_lt_u32 s52, 16
    s_cbranch_scc0 Lfn_20
    s_and_b32 s62, s52, 3
    s_cbranch_scc1 Lim_21
    s_lshr_b32 s62, s52, 2
    s_cmp_lt_u32 s62, 29
    s_cbranch_scc0 Liy_24
    s_and_b32 s63, s62, 0
    s_cbranch_scc1 Lal_27
    s_cmp_eq_u32 s62, 0
    s_cbranch_scc1 Lal_27
    s_add_u32 s51, s51, 4
    s_sub_u32 s66, s51, 1
    s_mov_b64 exec, 1
    ds_add_u32 v178, v19 offset:28
    s_mov_b64 exec, -1
Lw_28:
    ds_read_b32 v13, v178 offset:28
    s_waitcnt lgkmcnt(0)
    v_readfirstlane_b32 s90, v13
    s_nop 0
    s_cmp_gt_u32 s90, s66
    s_cbranch_scc1 Lwd_29
    s_sub_u32 s96, s96, 1
    s_cbranch_scc1 Labort
    s_branch Lw_28
Lwd_29:
    s_lshr_b32 s62, s52, 2
Lal_27:
    s_and_b32 s63, s62, 3
    s_lshl_b32 s63, s63, 5
    s_add_u32 s71, s63, s48
    s_bfe_u32 s63, s62, 0x20002
    s_cmp_lt_u32 s62, 16
    s_cselect_b32 s36, s6, s8
    s_cselect_b32 s37, s92, s93
    s_branch Lih_25
Liy_24:
    s_and_b32 s63, s64, 3
    s_lshl_b32 s63, s63, 2
    s_add_u32 s63, s63, s50
    v_mov_b32 v21, s63
Lw_30:
    ds_read_b32 v22, v18 offset:112
    s_waitcnt lgkmcnt(0)
    v_readfirstlane_b32 s90, v22
    s_nop 0
    s_cmp_gt_u32 s90, s64
    s_cbranch_scc1 Lwd_31
    s_sleep 1
    s_sub_u32 s96, s96, 1
    s_cbranch_scc1 Labort
    s_branch Lw_30
Lwd_31:
    ds_read_b32 v13, v21
    s_waitcnt lgkmcnt(0)
    v_readfirstlane_b32 s71, v13
    s_add_u32 s64, s64, 1
    s_cmp_ge_u32 s71, 96
    s_cbranch_scc1 Lis_22
    s_add_u32 s71, s71, 32
    s_mov_b32 s63, 3
    s_lshr_b32 s62, s52, 2
Lih_25:
    s_mul_i32 s63, s63, 50331648
    s_add_u32 s53, s61, s63
    s_add_u32 s63, s71, s49
    s_and_b32 s63, s63, 127
    s_mul_i32 s63, s63, 12288
    s_add_u32 s53, s53, s63
    s_cmp_ge_u32 s62, 28
    s_cbranch_scc0 Lim_21
    s_and_b32 s62, s65, 3
    s_lshl_b32 s62, s62, 2
    s_add_u32 s62, s62, s94
    v_mov_b32 v13, s62
    v_mov_b32 v21, s71
    s_add_u32 s65, s65, 1
    v_mov_b32 v22, s65
    s_mov_b64 exec, 1
    ds_write_b32 v13, v21
    ds_write_b32 v18, v22 offset:80
    s_mov_b64 exec, -1
Lim_21:
    s_cmp_lt_u32 s52, 116
    s_cbranch_scc1 Ln1_32
    s_waitcnt vmcnt(9)
    s_branch Ln2_33
Ln1_32:
    s_waitcnt vmcnt(5)
Ln2_33:
    s_mov_b32 m0, s54
    s_add_u32 s54, s54, 3072
    buffer_load_dwordx4 v2, s[36:39], s53 offen nt lds
    s_cmp_lt_u32 s52, 116
    s_cbranch_scc0 Lpw_34
    s_waitcnt vmcnt(5)
Lpw_34:
    buffer_load_dwordx4 v3, s[36:39], s53 offen offset:1024 nt lds
    s_cmp_lt_u32 s52, 116
    s_cbranch_scc0 Lpw_35
    s_waitcnt vmcnt(5)
Lpw_35:
    buffer_load_dwordx4 v4, s[36:39], s53 offen offset:2048 nt lds
    s_cmp_eq_u32 s54, s56
    s_cselect_b32 s54, s55, s54
    s_add_u32 s53, s53, 3072
    s_add_u32 s52, s52, 1
    s_branch Lid_23
Lis_22:
    s_mov_b32 s60, 1
    s_and_b32 s62, s65, 3
    s_lshl_b32 s62, s62, 2
    s_add_u32 s62, s62, s94
    v_mov_b32 v13, s62
    v_mov_b32 v21, 0xffff
    s_add_u32 s65, s65, 1
    v_mov_b32 v22, s65
    s_mov_b64 exec, 1
    ds_write_b32 v13, v21
    ds_write_b32 v18, v22 offset:80
    s_mov_b64 exec, -1
Lid_23:
    s_branch Lf_18
Lfn_20:
    s_sleep 1
    s_sub_u32 s96, s96, 1
    s_cbranch_scc1 Labort
    s_branch Lf_18
Lfd_19:
    s_waitcnt lgkmcnt(0)
    s_add_u32 s32, s32, 0x9e3779b9
Lloop_36:
    s_lshl_b32 s59, s57, 2
    s_add_u32 s59, s59, 7
    s_cmp_ge_u32 s57, 28
    s_cselect_b32 s62, 1, 0
    s_add_u32 s59, s59, s62
Liss_37:
    s_cmp_lt_u32 s52, s59
    s_cbranch_scc0 Lhave_39
    s_cmp_eq_u32 s60, 0
    s_cbranch_scc0 Lgo_38
    s_and_b32 s62, s52, 3
    s_cbranch_scc1 Lim_43
    s_lshr_b32 s62, s52, 2
    s_cmp_lt_u32 s62, 29
    s_cbranch_scc0 Liy_46
    s_and_b32 s63, s62, 0
    s_cbranch_scc1 Lal_49
    s_cmp_eq_u32 s62, 0
    s_cbranch_scc1 Lal_49
    s_add_u32 s51, s51, 4
    s_sub_u32 s66, s51, 1
    s_mov_b64 exec, 1
    ds_add_u32 v178, v19 offset:28
    s_mov_b64 exec, -1
Lw_50:
    ds_read_b32 v13, v178 offset:28
    s_waitcnt lgkmcnt(0)
    v_readfirstlane_b32 s90, v13
    s_nop 0
    s_cmp_gt_u32 s90, s66
    s_cbranch_scc1 Lwd_51
    s_sub_u32 s96, s96, 1
    s_cbranch_scc1 Labort
    s_branch Lw_50
Lwd_51:
    s_lshr_b32 s62, s52, 2
Lal_49:
    s_and_b32 s63, s62, 3
    s_lshl_b32 s63, s63, 5
    s_add_u32 s71, s63, s48
    s_bfe_u32 s63, s62, 0x20002
    s_cmp_lt_u32 s62, 16
    s_cselect_b32 s36, s6, s8
    s_cselect_b32 s37, s92, s93
    s_branch Lih_47
Liy_46:
    s_and_b32 s63, s64, 3
    s_lshl_b32 s63, s63, 2
    s_add_u32 s63, s63, s50
    v_mov_b32 v21, s63
Lw_52:
    ds_read_b32 v22, v18 offset:112
    s_waitcnt lgkmcnt(0)
    v_readfirstlane_b32 s90, v22
    s_nop 0
    s_cmp_gt_u32 s90, s64
    s_cbranch_scc1 Lwd_53
    s_sleep 1
    s_sub_u32 s96, s96, 1
    s_cbranch_scc1 Labort
    s_branch Lw_52
Lwd_53:
    ds_read_b32 v13, v21
    s_waitcnt lgkmcnt(0)
    v_readfirstlane_b32 s71, v13
    s_add_u32 s64, s64, 1
    s_cmp_ge_u32 s71, 96
    s_cbranch_scc1 Lis_44
    s_add_u32 s71, s71, 32
    s_mov_b32 s63, 3
    s_lshr_b32 s62, s52, 2
Lih_47:
    s_mul_i32 s63, s63, 50331648
    s_add_u32 s53, s61, s63
    s_add_u32 s63, s71, s49
    s_and_b32 s63, s63, 127
    s_mul_i32 s63, s63, 12288
    s_add_u32 s53, s53, s63
    s_cmp_ge_u32 s62, 28
    s_cbranch_scc0 Lim_43
    s_and_b32 s62, s65, 3
    s_lshl_b32 s62, s62, 2
    s_add_u32 s62, s62, s94
    v_mov_b32 v13, s62
    v_mov_b32 v21, s71
    s_add_u32 s65, s65, 1
    v_mov_b32 v22, s65
    s_mov_b64 exec, 1
    ds_write_b32 v13, v21
    ds_write_b32 v18, v22 offset:80
    s_mov_b64 exec, -1
Lim_43:
    s_cmp_lt_u32 s52, 116
    s_cbranch_scc1 Ln1_54
    s_waitcnt vmcnt(9)
    s_branch Ln2_55
Ln1_54:
    s_waitcnt vmcnt(5)
Ln2_55:
    s_mov_b32 m0, s54
    s_add_u32 s54, s54, 3072
    buffer_load_dwordx4 v2, s[36:39], s53 offen nt lds
    s_cmp_lt_u32 s52, 116
    s_cbranch_scc0 Lpw_56
    s_waitcnt vmcnt(5)
Lpw_56:
    buffer_load_dwordx4 v3, s[36:39], s53 offen offset:1024 nt lds
    s_cmp_lt_u32 s52, 116
    s_cbranch_scc0 Lpw_57
    s_waitcnt vmcnt(5)
Lpw_57:
    buffer_load_dwordx4 v4, s[36:39], s53 offen offset:2048 nt lds
    s_cmp_eq_u32 s54, s56
    s_cselect_b32 s54, s55, s54
    s_add_u32 s53, s53, 3072
    s_add_u32 s52, s52, 1
    s_branch Lid_45
Lis_44:
    s_mov_b32 s60, 1
    s_and_b32 s62, s65, 3
    s_lshl_b32 s62, s62, 2
    s_add_u32 s62, s62, s94
    v_mov_b32 v13, s62
    v_mov_b32 v21, 0xffff
    s_add_u32 s65, s65, 1
    v_mov_b32 v22, s65
    s_mov_b64 exec, 1
    ds_write_b32 v13, v21
    ds_write_b32 v18, v22 offset:80
    s_mov_b64 exec, -1
Lid_45:
    s_branch Liss_37
Lgo_38:
    s_lshl_b32 s62, s57, 2
    s_cmp_eq_u32 s62, s52
    s_cbranch_scc1 Lfin_42
    s_waitcnt vmcnt(0)
Lhave_39:
    s_cmp_lt_u32 s57, 16
    s_cbranch_scc0 Lvit_40
    v_add_u32 v14, s58, v5
    v_add_u32 v15, s58, v6
    s_and_b32 s62, s57, 3
    s_cbranch_scc1 Lkq_58
    s_lshr_b32 s62, s57, 2
    s_mul_i32 s62, s62, 384
    v_add_u32 v13, s62, v181
    ds_read_b128 v[24:27], v13 offset:0
    ds_read_b128 v[28:31], v13 offset:64
    ds_read_b128 v[32:35], v13 offset:128
    ds_read_b128 v[36:39], v13 offset:192
    ds_read_b128 v[40:43], v13 offset:256
    ds_read_b128 v[44:47], v13 offset:320
    v_mov_b32 v192, 0xff800000
    v_mov_b32 v193, 0
    s_waitcnt lgkmcnt(0)
Lkq_58:
    s_cmp_eq_u32 s57, 0
    s_cbranch_scc1 Lpr0_59
    ds_read_b128 v[48:51], v14 offset:0
    ds_read_b128 v[52:55], v14 offset:6144
    ds_read_b128 v[56:59], v15 offset:0
    ds_read_b128 v[60:63], v15 offset:6144
    ds_read_b128 v[64:67], v14 offset:128
    ds_read_b128 v[68:71], v14 offset:6272
    ds_read_b128 v[72:75], v15 offset:128
    ds_read_b128 v[76:79], v15 offset:6272
    ds_read_b128 v[80:83], v14 offset:256
    ds_read_b128 v[84:87], v14 offset:6400
    ds_read_b128 v[88:91], v15 offset:256
    ds_read_b128 v[92:95], v15 offset:6400
Lpr0_59:
    s_waitcnt lgkmcnt(10)
    v_mfma_f32_16x16x32_bf16 v[96:99], v[48:51], v[24:27], 0
    v_mfma_f32_16x16x32_bf16 v[100:103], v[52:55], v[24:27], 0
    s_waitcnt lgkmcnt(8)
    v_mfma_f32_16x16x32_bf16 v[96:99], v[56:59], v[28:31], v[96:99]
    v_mfma_f32_16x16x32_bf16 v[100:103], v[60:63], v[28:31], v[100:103]
    s_waitcnt lgkmcnt(6)
    v_mfma_f32_16x16x32_bf16 v[96:99], v[64:67], v[32:35], v[96:99]
    v_mfma_f32_16x16x32_bf16 v[100:103], v[68:71], v[32:35], v[100:103]
    s_waitcnt lgkmcnt(4)
    v_mfma_f32_16x16x32_bf16 v[96:99], v[72:75], v[36:39], v[96:99]
    v_mfma_f32_16x16x32_bf16 v[100:103], v[76:79], v[36:39], v[100:103]
    s_waitcnt lgkmcnt(2)
    v_mfma_f32_16x16x32_bf16 v[96:99], v[80:83], v[40:43], v[96:99]
    v_mfma_f32_16x16x32_bf16 v[100:103], v[84:87], v[40:43], v[100:103]
    s_waitcnt lgkmcnt(0)
    v_mfma_f32_16x16x32_bf16 v[96:99], v[88:91], v[44:47], v[96:99]
    v_mfma_f32_16x16x32_bf16 v[100:103], v[92:95], v[44:47], v[100:103]
    s_getreg_b32 s63, hwreg(HW_REG_IB_STS, 0, 4)
    s_cmp_le_u32 s63, 3
    s_cbranch_scc0 Lti_60
    s_and_b32 s63, s52, 3
    s_cbranch_scc0 Lti_60
    s_waitcnt vmcnt(5)
    s_mov_b32 m0, s54
    s_add_u32 s54, s54, 3072
    buffer_load_dwordx4 v2, s[36:39], s53 offen nt lds
    buffer_load_dwordx4 v3, s[36:39], s53 offen offset:1024 nt lds
    buffer_load_dwordx4 v4, s[36:39], s53 offen offset:2048 nt lds
    s_cmp_eq_u32 s54, s56
    s_cselect_b32 s54, s55, s54
    s_add_u32 s53, s53, 3072
    s_add_u32 s52, s52, 1
Lti_60:
    s_lshl_b32 s62, s57, 6
    v_add_u32 v13, s62, v180
    s_nop 6
    v_cvt_pk_bf16_f32 v164, v96, v97
    v_lshlrev_b32 v156, 16, v164
    v_and_b32 v157, 0xffff0000, v164
    v_mul_f32 v156, 0x3d93cd3a, v156
    v_mul_f32 v157, 0x3d93cd3a, v157
    v_cvt_pk_bf16_f32 v184, v156, v157
    v_lshlrev_b32 v156, 16, v184
    v_and_b32 v157, 0xffff0000, v184
    v_cvt_pk_bf16_f32 v164, v98, v99
    v_lshlrev_b32 v158, 16, v164
    v_and_b32 v159, 0xffff0000, v164
    v_mul_f32 v158, 0x3d93cd3a, v158
    v_mul_f32 v159, 0x3d93cd3a, v159
    v_cvt_pk_bf16_f32 v185, v158, v159
    v_lshlrev_b32 v158, 16, v185
    v_and_b32 v159, 0xffff0000, v185
    v_cvt_pk_bf16_f32 v164, v100, v101
    v_lshlrev_b32 v160, 16, v164
    v_and_b32 v161, 0xffff0000, v164
    v_mul_f32 v160, 0x3d93cd3a, v160
    v_mul_f32 v161, 0x3d93cd3a, v161
    v_cvt_pk_bf16_f32 v186, v160, v161
    v_lshlrev_b32 v160, 16, v186
    v_and_b32 v161, 0xffff0000, v186
    v_cvt_pk_bf16_f32 v164, v102, v103
    v_lshlrev_b32 v162, 16, v164
    v_and_b32 v163, 0xffff0000, v164
    v_mul_f32 v162, 0x3d93cd3a, v162
    v_mul_f32 v163, 0x3d93cd3a, v163
    v_cvt_pk_bf16_f32 v187, v162, v163
    v_lshlrev_b32 v162, 16, v187
    v_and_b32 v163, 0xffff0000, v187
    s_mov_b32 exec_lo, 0x00010001
    s_mov_b32 exec_hi, 0x00010001
    ds_write_b128 v13, v[184:187]
    s_mov_b64 exec, -1
    s_getreg_b32 s63, hwreg(HW_REG_IB_STS, 0, 4)
    s_cmp_le_u32 s63, 3
    s_cbranch_scc0 Lti_61
    s_and_b32 s63, s52, 3
    s_cbranch_scc0 Lti_61
    s_waitcnt vmcnt(5)
    s_mov_b32 m0, s54
    s_add_u32 s54, s54, 3072
    buffer_load_dwordx4 v2, s[36:39], s53 offen nt lds
    buffer_load_dwordx4 v3, s[36:39], s53 offen offset:1024 nt lds
    buffer_load_dwordx4 v4, s[36:39], s53 offen offset:2048 nt lds
    s_cmp_eq_u32 s54, s56
    s_cselect_b32 s54, s55, s54
    s_add_u32 s53, s53, 3072
    s_add_u32 s52, s52, 1
Lti_61:
    v_max3_f32 v164, v156, v157, v158
    v_max3_f32 v164, v164, v159, v160
    v_max3_f32 v164, v164, v161, v162
    v_max3_f32 v164, v164, v163, v192
    v_sub_f32 v165, v192, v164
    v_mul_f32 v165, 0x3fb8aa3b, v165
    v_mov_b32 v192, v164
    v_sub_f32 v196, v156, v192
    v_mul_f32 v196, 0x3fb8aa3b, v196
    v_sub_f32 v197, v157, v192
    v_mul_f32 v197, 0x3fb8aa3b, v197
    v_sub_f32 v198, v158, v192
    v_mul_f32 v198, 0x3fb8aa3b, v198
    v_sub_f32 v199, v159, v192
    v_mul_f32 v199, 0x3fb8aa3b, v199
    v_sub_f32 v200, v160, v192
    v_mul_f32 v200, 0x3fb8aa3b, v200
    v_sub_f32 v201, v161, v192
    v_mul_f32 v201, 0x3fb8aa3b, v201
    v_sub_f32 v202, v162, v192
    v_mul_f32 v202, 0x3fb8aa3b, v202
    v_sub_f32 v203, v163, v192
    v_mul_f32 v203, 0x3fb8aa3b, v203
    v_exp_f32 v165, v165
    v_exp_f32 v196, v196
    v_exp_f32 v197, v197
    v_exp_f32 v198, v198
    v_exp_f32 v199, v199
    v_exp_f32 v200, v200
    v_exp_f32 v201, v201
    v_exp_f32 v202, v202
    v_exp_f32 v203, v203
    s_getreg_b32 s63, hwreg(HW_REG_IB_STS, 0, 4)
    s_cmp_le_u32 s63, 3
    s_cbranch_scc0 Lti_62
    s_and_b32 s63, s52, 3
    s_cbranch_scc0 Lti_62
    s_waitcnt vmcnt(5)
    s_mov_b32 m0, s54
    s_add_u32 s54, s54, 3072
    buffer_load_dwordx4 v2, s[36:39], s53 offen nt lds
    buffer_load_dwordx4 v3, s[36:39], s53 offen offset:1024 nt lds
    buffer_load_dwordx4 v4, s[36:39], s53 offen offset:2048 nt lds
    s_cmp_eq_u32 s54, s56
    s_cselect_b32 s54, s55, s54
    s_add_u32 s53, s53, 3072
    s_add_u32 s52, s52, 1
Lti_62:
    v_mul_f32 v193, v193, v165
    v_add_f32 v196, v196, v197
    v_add_f32 v198, v198, v199
    v_add_f32 v200, v200, v201
    v_add_f32 v202, v202, v203
    v_add_f32 v196, v196, v198
    v_add_f32 v200, v200, v202
    v_add_f32 v196, v196, v200
    v_add_f32 v193, v193, v196
    s_and_b32 s62, s57, 3
    s_cmp_eq_u32 s62, 3
    s_cbranch_scc0 Lnext_41
    v_mov_b32 v164, v192
    v_mov_b32 v165, v164
    s_nop 1
    v_permlane16_swap_b32 v165, v164
    v_max_f32 v164, v165, v164
    v_mov_b32 v165, v164
    s_nop 1
    v_permlane32_swap_b32 v165, v164
    v_max_f32 v164, v165, v164
    v_sub_f32 v165, v192, v164
    v_mul_f32 v165, 0x3fb8aa3b, v165
    v_exp_f32 v165, v165
    s_nop 0
    v_mul_f32 v193, v193, v165
    v_mov_b32 v165, v193
    s_nop 1
    v_permlane16_swap_b32 v165, v193
    v_add_f32 v193, v165, v193
    v_mov_b32 v165, v193
    s_nop 1
    v_permlane32_swap_b32 v165, v193
    v_add_f32 v193, v165, v193
    v_mov_b32 v196, v164
    v_mov_b32 v197, v193
    s_lshr_b32 s63, s57, 2
    s_lshl_b32 s62, s33, 2
    s_add_u32 s62, s62, s63
    s_lshl_b32 s62, s62, 3
    s_add_u32 s62, s62, 162304
    v_mov_b32 v13, s62
    s_add_u32 s63, s63, 1
    v_mov_b32 v14, s63
    s_mov_b64 exec, 1
    ds_write_b64 v13, v[196:197]
    ds_write_b32 v18, v14 offset:32
    s_mov_b64 exec, -1
    s_branch Lnext_41
Lvit_40:
    s_sub_u32 s66, s57, 16
    s_cmp_lt_u32 s66, 13
    s_cbranch_scc0 Lvp_63
    s_and_b32 s62, s66, 3
    s_cbranch_scc1 Lvs_65
    s_lshr_b32 s67, s66, 2
Lw_66:
    ds_read_b32 v13, v18 offset:48
    s_waitcnt lgkmcnt(0)
    v_readfirstlane_b32 s90, v13
    s_nop 0
    s_cmp_gt_u32 s90, s67
    s_cbranch_scc1 Lwd_67
    s_lshl_b32 s62, s57, 2
    s_add_u32 s62, s62, 12
    s_cmp_lt_u32 s52, s62
    s_cbranch_scc0 Lra_68
    s_cmp_eq_u32 s60, 0
    s_cbranch_scc0 Lra_68
    s_and_b32 s62, s52, 3
    s_cbranch_scc1 Lim_69
    s_lshr_b32 s62, s52, 2
    s_cmp_lt_u32 s62, 29
    s_cbranch_scc0 Liy_72
    s_and_b32 s63, s62, 0
    s_cbranch_scc1 Lal_75
    s_cmp_eq_u32 s62, 0
    s_cbranch_scc1 Lal_75
    s_add_u32 s51, s51, 4
    s_sub_u32 s66, s51, 1
    s_mov_b64 exec, 1
    ds_add_u32 v178, v19 offset:28
    s_mov_b64 exec, -1
Lw_76:
    ds_read_b32 v13, v178 offset:28
    s_waitcnt lgkmcnt(0)
    v_readfirstlane_b32 s90, v13
    s_nop 0
    s_cmp_gt_u32 s90, s66
    s_cbranch_scc1 Lwd_77
    s_sub_u32 s96, s96, 1
    s_cbranch_scc1 Labort
    s_branch Lw_76
Lwd_77:
    s_lshr_b32 s62, s52, 2
Lal_75:
    s_and_b32 s63, s62, 3
    s_lshl_b32 s63, s63, 5
    s_add_u32 s71, s63, s48
    s_bfe_u32 s63, s62, 0x20002
    s_cmp_lt_u32 s62, 16
    s_cselect_b32 s36, s6, s8
    s_cselect_b32 s37, s92, s93
    s_branch Lih_73
Liy_72:
    s_and_b32 s63, s64, 3
    s_lshl_b32 s63, s63, 2
    s_add_u32 s63, s63, s50
    v_mov_b32 v21, s63
Lw_78:
    ds_read_b32 v22, v18 offset:112
    s_waitcnt lgkmcnt(0)
    v_readfirstlane_b32 s90, v22
    s_nop 0
    s_cmp_gt_u32 s90, s64
    s_cbranch_scc1 Lwd_79
    s_sleep 1
    s_sub_u32 s96, s96, 1
    s_cbranch_scc1 Labort
    s_branch Lw_78
Lwd_79:
    ds_read_b32 v13, v21
    s_waitcnt lgkmcnt(0)
    v_readfirstlane_b32 s71, v13
    s_add_u32 s64, s64, 1
    s_cmp_ge_u32 s71, 96
    s_cbranch_scc1 Lis_70
    s_add_u32 s71, s71, 32
    s_mov_b32 s63, 3
    s_lshr_b32 s62, s52, 2
Lih_73:
    s_mul_i32 s63, s63, 50331648
    s_add_u32 s53, s61, s63
    s_add_u32 s63, s71, s49
    s_and_b32 s63, s63, 127
    s_mul_i32 s63, s63, 12288
    s_add_u32 s53, s53, s63
    s_cmp_ge_u32 s62, 28
    s_cbranch_scc0 Lim_69
    s_and_b32 s62, s65, 3
    s_lshl_b32 s62, s62, 2
    s_add_u32 s62, s62, s94
    v_mov_b32 v13, s62
    v_mov_b32 v21, s71
    s_add_u32 s65, s65, 1
    v_mov_b32 v22, s65
    s_mov_b64 exec, 1
    ds_write_b32 v13, v21
    ds_write_b32 v18, v22 offset:80
    s_mov_b64 exec, -1
Lim_69:
    s_cmp_lt_u32 s52, 116
    s_cbranch_scc1 Ln1_80
    s_waitcnt vmcnt(9)
    s_branch Ln2_81
Ln1_80:
    s_waitcnt vmcnt(5)
Ln2_81:
    s_mov_b32 m0, s54
    s_add_u32 s54, s54, 3072
    buffer_load_dwordx4 v2, s[36:39], s53 offen nt lds
    s_cmp_lt_u32 s52, 116
    s_cbranch_scc0 Lpw_82
    s_waitcnt vmcnt(5)
Lpw_82:
    buffer_load_dwordx4 v3, s[36:39], s53 offen offset:1024 nt lds
    s_cmp_lt_u32 s52, 116
    s_cbranch_scc0 Lpw_83
    s_waitcnt vmcnt(5)
Lpw_83:
    buffer_load_dwordx4 v4, s[36:39], s53 offen offset:2048 nt lds
    s_cmp_eq_u32 s54, s56
    s_cselect_b32 s54, s55, s54
    s_add_u32 s53, s53, 3072
    s_add_u32 s52, s52, 1
    s_branch Lid_71
Lis_70:
    s_mov_b32 s60, 1
    s_and_b32 s62, s65, 3
    s_lshl_b32 s62, s62, 2
    s_add_u32 s62, s62, s94
    v_mov_b32 v13, s62
    v_mov_b32 v21, 0xffff
    s_add_u32 s65, s65, 1
    v_mov_b32 v22, s65
    s_mov_b64 exec, 1
    ds_write_b32 v13, v21
    ds_write_b32 v18, v22 offset:80
    s_mov_b64 exec, -1
Lid_71:
Lra_68:
    s_sleep 1
    s_sub_u32 s96, s96, 1
    s_cbranch_scc1 Labort
    s_branch Lw_66
Lwd_67:
Lvs_65:
    s_sub_u32 s62, s57, 16
    s_lshl_b32 s62, s62, 6
    v_add_u32 v13, s62, v180
    s_branch Lvo_64
Lvp_63:
Lw_84:
    ds_read_b32 v13, v18 offset:96
    s_waitcnt lgkmcnt(0)
    v_readfirstlane_b32 s90, v13
    s_nop 0
    s_cmp_gt_u32 s90, s69
    s_cbranch_scc1 Lwd_85
    s_lshl_b32 s62, s57, 2
    s_add_u32 s62, s62, 12
    s_cmp_lt_u32 s52, s62
    s_cbranch_scc0 Lra_86
    s_cmp_eq_u32 s60, 0
    s_cbranch_scc0 Lra_86
    s_and_b32 s62, s52, 3
    s_cbranch_scc1 Lim_87
    s_lshr_b32 s62, s52, 2
    s_cmp_lt_u32 s62, 29
    s_cbranch_scc0 Liy_90
    s_and_b32 s63, s62, 0
    s_cbranch_scc1 Lal_93
    s_cmp_eq_u32 s62, 0
    s_cbranch_scc1 Lal_93
    s_add_u32 s51, s51, 4
    s_sub_u32 s66, s51, 1
    s_mov_b64 exec, 1
    ds_add_u32 v178, v19 offset:28
    s_mov_b64 exec, -1
Lw_94:
    ds_read_b32 v13, v178 offset:28
    s_waitcnt lgkmcnt(0)
    v_readfirstlane_b32 s90, v13
    s_nop 0
    s_cmp_gt_u32 s90, s66
    s_cbranch_scc1 Lwd_95
    s_sub_u32 s96, s96, 1
    s_cbranch_scc1 Labort
    s_branch Lw_94
Lwd_95:
    s_lshr_b32 s62, s52, 2
Lal_93:
    s_and_b32 s63, s62, 3
    s_lshl_b32 s63, s63, 5
    s_add_u32 s71, s63, s48
    s_bfe_u32 s63, s62, 0x20002
    s_cmp_lt_u32 s62, 16
    s_cselect_b32 s36, s6, s8
    s_cselect_b32 s37, s92, s93
    s_branch Lih_91
Liy_90:
    s_and_b32 s63, s64, 3
    s_lshl_b32 s63, s63, 2
    s_add_u32 s63, s63, s50
    v_mov_b32 v21, s63
Lw_96:
    ds_read_b32 v22, v18 offset:112
    s_waitcnt lgkmcnt(0)
    v_readfirstlane_b32 s90, v22
    s_nop 0
    s_cmp_gt_u32 s90, s64
    s_cbranch_scc1 Lwd_97
    s_sleep 1
    s_sub_u32 s96, s96, 1
    s_cbranch_scc1 Labort
    s_branch Lw_96
Lwd_97:
    ds_read_b32 v13, v21
    s_waitcnt lgkmcnt(0)
    v_readfirstlane_b32 s71, v13
    s_add_u32 s64, s64, 1
    s_cmp_ge_u32 s71, 96
    s_cbranch_scc1 Lis_88
    s_add_u32 s71, s71, 32
    s_mov_b32 s63, 3
    s_lshr_b32 s62, s52, 2
Lih_91:
    s_mul_i32 s63, s63, 50331648
    s_add_u32 s53, s61, s63
    s_add_u32 s63, s71, s49
    s_and_b32 s63, s63, 127
    s_mul_i32 s63, s63, 12288
    s_add_u32 s53, s53, s63
    s_cmp_ge_u32 s62, 28
    s_cbranch_scc0 Lim_87
    s_and_b32 s62, s65, 3
    s_lshl_b32 s62, s62, 2
    s_add_u32 s62, s62, s94
    v_mov_b32 v13, s62
    v_mov_b32 v21, s71
    s_add_u32 s65, s65, 1
    v_mov_b32 v22, s65
    s_mov_b64 exec, 1
    ds_write_b32 v13, v21
    ds_write_b32 v18, v22 offset:80
    s_mov_b64 exec, -1
Lim_87:
    s_cmp_lt_u32 s52, 116
    s_cbranch_scc1 Ln1_98
    s_waitcnt vmcnt(9)
    s_branch Ln2_99
Ln1_98:
    s_waitcnt vmcnt(5)
Ln2_99:
    s_mov_b32 m0, s54
    s_add_u32 s54, s54, 3072
    buffer_load_dwordx4 v2, s[36:39], s53 offen nt lds
    s_cmp_lt_u32 s52, 116
    s_cbranch_scc0 Lpw_100
    s_waitcnt vmcnt(5)
Lpw_100:
    buffer_load_dwordx4 v3, s[36:39], s53 offen offset:1024 nt lds
    s_cmp_lt_u32 s52, 116
    s_cbranch_scc0 Lpw_101
    s_waitcnt vmcnt(5)
Lpw_101:
    buffer_load_dwordx4 v4, s[36:39], s53 offen offset:2048 nt lds
    s_cmp_eq_u32 s54, s56
    s_cselect_b32 s54, s55, s54
    s_add_u32 s53, s53, 3072
    s_add_u32 s52, s52, 1
    s_branch Lid_89
Lis_88:
    s_mov_b32 s60, 1
    s_and_b32 s62, s65, 3
    s_lshl_b32 s62, s62, 2
    s_add_u32 s62, s62, s94
    v_mov_b32 v13, s62
    v_mov_b32 v21, 0xffff
    s_add_u32 s65, s65, 1
    v_mov_b32 v22, s65
    s_mov_b64 exec, 1
    ds_write_b32 v13, v21
    ds_write_b32 v18, v22 offset:80
    s_mov_b64 exec, -1
Lid_89:
Lra_86:
    s_sleep 1
    s_sub_u32 s96, s96, 1
    s_cbranch_scc1 Labort
    s_branch Lw_84
Lwd_85:
    s_and_b32 s62, s69, 3
    s_lshl_b32 s62, s62, 6
    v_add_u32 v13, s62, v12
    s_add_u32 s69, s69, 1
Lvo_64:
    v_add_u32 v14, s58, v7
    v_add_u32 v15, s58, v8
    v_add_u32 v16, s58, v9
    v_add_u32 v17, s58, v10
    ds_read_b128 v[152:155], v13
    ds_read_b64_tr_b16 v[48:49], v14 offset:0
    ds_read_b64_tr_b16 v[50:51], v14 offset:6144
    ds_read_b64_tr_b16 v[52:53], v15 offset:0
    ds_read_b64_tr_b16 v[54:55], v15 offset:6144
    ds_read_b64_tr_b16 v[56:57], v16 offset:0
    ds_read_b64_tr_b16 v[58:59], v16 offset:6144
    ds_read_b64_tr_b16 v[60:61], v17 offset:0
    ds_read_b64_tr_b16 v[62:63], v17 offset:6144
    ds_read_b64_tr_b16 v[64:65], v14 offset:128
    ds_read_b64_tr_b16 v[66:67], v14 offset:6272
    ds_read_b64_tr_b16 v[68:69], v15 offset:128
    ds_read_b64_tr_b16 v[70:71], v15 offset:6272
    s_waitcnt lgkmcnt(6)
    v_mfma_f32_16x16x32_bf16 v[104:107], v[152:155], v[48:51], v[104:107]
    v_mfma_f32_16x16x32_bf16 v[108:111], v[152:155], v[52:55], v[108:111]
    v_mfma_f32_16x16x32_bf16 v[112:115], v[152:155], v[56:59], v[112:115]
    s_getreg_b32 s63, hwreg(HW_REG_IB_STS, 0, 4)
    s_cmp_le_u32 s63, 3
    s_cbranch_scc0 Lti_102
    s_and_b32 s63, s52, 3
    s_cbranch_scc0 Lti_102
    s_waitcnt vmcnt(5)
    s_mov_b32 m0, s54
    s_add_u32 s54, s54, 3072
    buffer_load_dwordx4 v2, s[36:39], s53 offen nt lds
    buffer_load_dwordx4 v3, s[36:39], s53 offen offset:1024 nt lds
    buffer_load_dwordx4 v4, s[36:39], s53 offen offset:2048 nt lds
    s_cmp_eq_u32 s54, s56
    s_cselect_b32 s54, s55, s54
    s_add_u32 s53, s53, 3072
    s_add_u32 s52, s52, 1
Lti_102:
    ds_read_b64_tr_b16 v[72:73], v16 offset:128
    ds_read_b64_tr_b16 v[74:75], v16 offset:6272
    ds_read_b64_tr_b16 v[76:77], v17 offset:128
    ds_read_b64_tr_b16 v[78:79], v17 offset:6272
    ds_read_b64_tr_b16 v[80:81], v14 offset:256
    ds_read_b64_tr_b16 v[82:83], v14 offset:6400
    s_waitcnt lgkmcnt(6)
    v_mfma_f32_16x16x32_bf16 v[116:119], v[152:155], v[60:63], v[116:119]
    v_mfma_f32_16x16x32_bf16 v[120:123], v[152:155], v[64:67], v[120:123]
    v_mfma_f32_16x16x32_bf16 v[124:127], v[152:155], v[68:71], v[124:127]
    ds_read_b64_tr_b16 v[84:85], v15 offset:256
    ds_read_b64_tr_b16 v[86:87], v15 offset:6400
    ds_read_b64_tr_b16 v[88:89], v16 offset:256
    ds_read_b64_tr_b16 v[90:91], v16 offset:6400
    ds_read_b64_tr_b16 v[92:93], v17 offset:256
    ds_read_b64_tr_b16 v[94:95], v17 offset:6400
    s_waitcnt lgkmcnt(6)
    v_mfma_f32_16x16x32_bf16 v[128:131], v[152:155], v[72:75], v[128:131]
    v_mfma_f32_16x16x32_bf16 v[132:135], v[152:155], v[76:79], v[132:135]
    v_mfma_f32_16x16x32_bf16 v[136:139], v[152:155], v[80:83], v[136:139]
    s_waitcnt lgkmcnt(0)
    v_mfma_f32_16x16x32_bf16 v[140:143], v[152:155], v[84:87], v[140:143]
    v_mfma_f32_16x16x32_bf16 v[144:147], v[152:155], v[88:91], v[144:147]
    v_mfma_f32_16x16x32_bf16 v[148:151], v[152:155], v[92:95], v[148:151]
    s_getreg_b32 s63, hwreg(HW_REG_IB_STS, 0, 4)
    s_cmp_le_u32 s63, 3
    s_cbranch_scc0 Lti_103
    s_and_b32 s63, s52, 3
    s_cbranch_scc0 Lti_103
    s_waitcnt vmcnt(5)
    s_mov_b32 m0, s54
    s_add_u32 s54, s54, 3072
    buffer_load_dwordx4 v2, s[36:39], s53 offen nt lds
    buffer_load_dwordx4 v3, s[36:39], s53 offen offset:1024 nt lds
    buffer_load_dwordx4 v4, s[36:39], s53 offen offset:2048 nt lds
    s_cmp_eq_u32 s54, s56
    s_cselect_b32 s54, s55, s54
    s_add_u32 s53, s53, 3072
    s_add_u32 s52, s52, 1
Lti_103:
    s_sub_u32 s62, s57, 16
    s_cmp_lt_u32 s62, 12
    s_cbranch_scc0 Lnext_41
    s_and_b32 s63, s62, 3
    s_cmp_eq_u32 s63, 3
    s_cbranch_scc0 Lnext_41
    s_lshr_b32 s70, s62, 2
    s_sub_u32 s66, s70, 1
    s_cmp_eq_u32 s70, 0
    s_cbranch_scc1 Lfs_104
Lw_105:
    ds_read_b32 v13, v178 offset:24
    s_waitcnt lgkmcnt(0)
    v_readfirstlane_b32 s90, v13
    s_nop 0
    s_cmp_gt_u32 s90, s66
    s_cbranch_scc1 Lwd_106
    s_sleep 1
    s_sub_u32 s96, s96, 1
    s_cbranch_scc1 Labort
    s_branch Lw_105
Lwd_106:
Lfs_104:
    s_lshl_b32 s62, s70, 2
    s_add_u32 s62, s62, 162496
    v_mov_b32 v14, s62
    s_nop 4
    s_mov_b64 exec, 0xffff
    ds_write_b32 v182, v104 offset:0
    ds_write_b32 v182, v108 offset:64
    ds_write_b32 v182, v112 offset:128
    ds_write_b32 v182, v116 offset:192
    ds_write_b32 v182, v120 offset:256
    ds_write_b32 v182, v124 offset:320
    ds_write_b32 v182, v128 offset:384
    ds_write_b32 v182, v132 offset:448
    ds_write_b32 v182, v136 offset:512
    ds_write_b32 v182, v140 offset:576
    ds_write_b32 v182, v144 offset:640
    ds_write_b32 v182, v148 offset:704
    s_mov_b64 exec, 1
    ds_add_rtn_u32 v15, v14, v19
    s_mov_b64 exec, -1
    s_getreg_b32 s63, hwreg(HW_REG_IB_STS, 0, 4)
    s_cmp_le_u32 s63, 3
    s_cbranch_scc0 Lti_107
    s_and_b32 s63, s52, 3
    s_cbranch_scc0 Lti_107
    s_waitcnt vmcnt(5)
    s_mov_b32 m0, s54
    s_add_u32 s54, s54, 3072
    buffer_load_dwordx4 v2, s[36:39], s53 offen nt lds
    buffer_load_dwordx4 v3, s[36:39], s53 offen offset:1024 nt lds
    buffer_load_dwordx4 v4, s[36:39], s53 offen offset:2048 nt lds
    s_cmp_eq_u32 s54, s56
    s_cselect_b32 s54, s55, s54
    s_add_u32 s53, s53, 3072
    s_add_u32 s52, s52, 1
Lti_107:
    v_mov_b32 v104, 0
    v_mov_b32 v105, 0
    v_mov_b32 v106, 0
    v_mov_b32 v107, 0
    v_mov_b32 v108, 0
    v_mov_b32 v109, 0
    v_mov_b32 v110, 0
    v_mov_b32 v111, 0
    v_mov_b32 v112, 0
    v_mov_b32 v113, 0
    v_mov_b32 v114, 0
    v_mov_b32 v115, 0
    v_mov_b32 v116, 0
    v_mov_b32 v117, 0
    v_mov_b32 v118, 0
    v_mov_b32 v119, 0
    v_mov_b32 v120, 0
    v_mov_b32 v121, 0
    v_mov_b32 v122, 0
    v_mov_b32 v123, 0
    v_mov_b32 v124, 0
    v_mov_b32 v125, 0
    v_mov_b32 v126, 0
    v_mov_b32 v127, 0
    v_mov_b32 v128, 0
    v_mov_b32 v129, 0
    v_mov_b32 v130, 0
    v_mov_b32 v131, 0
    v_mov_b32 v132, 0
    v_mov_b32 v133, 0
    v_mov_b32 v134, 0
    v_mov_b32 v135, 0
    v_mov_b32 v136, 0
    v_mov_b32 v137, 0
    v_mov_b32 v138, 0
    v_mov_b32 v139, 0
    v_mov_b32 v140, 0
    v_mov_b32 v141, 0
    v_mov_b32 v142, 0
    v_mov_b32 v143, 0
    v_mov_b32 v144, 0
    v_mov_b32 v145, 0
    v_mov_b32 v146, 0
    v_mov_b32 v147, 0
    v_mov_b32 v148, 0
    v_mov_b32 v149, 0
    v_mov_b32 v150, 0
    v_mov_b32 v151, 0
    s_waitcnt lgkmcnt(0)
    v_readfirstlane_b32 s62, v15
    s_nop 0
    s_cmp_eq_u32 s62, 3
    s_cbranch_scc0 Lfn_108
    ds_read_b32 v48, v183 offset:0
    ds_read_b32 v49, v183 offset:4
    ds_read_b32 v50, v183 offset:8
    ds_read_b32 v52, v183 offset:768
    ds_read_b32 v53, v183 offset:772
    ds_read_b32 v54, v183 offset:776
    ds_read_b32 v56, v183 offset:1536
    ds_read_b32 v57, v183 offset:1540
    ds_read_b32 v58, v183 offset:1544
    ds_read_b32 v60, v183 offset:2304
    ds_read_b32 v61, v183 offset:2308
    ds_read_b32 v62, v183 offset:2312
    s_lshl_b32 s63, s34, 2
    s_add_u32 s63, s63, s70
    s_lshl_b32 s63, s63, 3
    s_add_u32 s63, s63, s35
    s_lshl_b32 s63, s63, 10
    s_add_u32 s63, s63, 1048576
    v_lshlrev_b32 v15, 4, v1
    v_mov_b32 v199, s32
    s_waitcnt lgkmcnt(6)
    v_add_f32 v196, v48, v52
    v_add_f32 v197, v49, v53
    v_add_f32 v198, v50, v54
    s_waitcnt lgkmcnt(0)
    v_add_f32 v56, v56, v60
    v_add_f32 v57, v57, v61
    v_add_f32 v58, v58, v62
    v_add_f32 v196, v196, v56
    v_add_f32 v197, v197, v57
    v_add_f32 v198, v198, v58
    buffer_store_dwordx4 v[196:199], v15, s[40:43], s63 offen sc1
    s_mov_b64 exec, 1
    ds_add_u32 v178, v19 offset:24
    s_mov_b64 exec, -1
Lfn_108:
Lnext_41:
    s_add_u32 s58, s58, 12288
    s_cmp_eq_u32 s58, s56
    s_cselect_b32 s58, s55, s58
    s_add_u32 s57, s57, 1
    s_branch Lloop_36
Lfin_42:
    s_mov_b32 s70, 3
    s_sub_u32 s66, s70, 1
    s_cmp_eq_u32 s70, 0
    s_cbranch_scc1 Lfs_109
Lw_110:
    ds_read_b32 v13, v178 offset:24
    s_waitcnt lgkmcnt(0)
    v_readfirstlane_b32 s90, v13
    s_nop 0
    s_cmp_gt_u32 s90, s66
    s_cbranch_scc1 Lwd_111
    s_sleep 1
    s_sub_u32 s96, s96, 1
    s_cbranch_scc1 Labort
    s_branch Lw_110
Lwd_111:
Lfs_109:
    s_lshl_b32 s62, s70, 2
    s_add_u32 s62, s62, 162496
    v_mov_b32 v14, s62
    s_nop 4
    s_mov_b64 exec, 0xffff
    ds_write_b32 v182, v104 offset:0
    ds_write_b32 v182, v108 offset:64
    ds_write_b32 v182, v112 offset:128
    ds_write_b32 v182, v116 offset:192
    ds_write_b32 v182, v120 offset:256
    ds_write_b32 v182, v124 offset:320
    ds_write_b32 v182, v128 offset:384
    ds_write_b32 v182, v132 offset:448
    ds_write_b32 v182, v136 offset:512
    ds_write_b32 v182, v140 offset:576
    ds_write_b32 v182, v144 offset:640
    ds_write_b32 v182, v148 offset:704
    s_mov_b64 exec, 1
    ds_add_rtn_u32 v15, v14, v19
    s_mov_b64 exec, -1
    s_waitcnt lgkmcnt(0)
    v_readfirstlane_b32 s62, v15
    s_nop 0
    s_cmp_eq_u32 s62, 3
    s_cbranch_scc0 Lfn_112
    ds_read_b32 v48, v183 offset:0
    ds_read_b32 v49, v183 offset:4
    ds_read_b32 v50, v183 offset:8
    ds_read_b32 v52, v183 offset:768
    ds_read_b32 v53, v183 offset:772
    ds_read_b32 v54, v183 offset:776
    ds_read_b32 v56, v183 offset:1536
    ds_read_b32 v57, v183 offset:1540
    ds_read_b32 v58, v183 offset:1544
    ds_read_b32 v60, v183 offset:2304
    ds_read_b32 v61, v183 offset:2308
    ds_read_b32 v62, v183 offset:2312
    s_lshl_b32 s63, s34, 2
    s_add_u32 s63, s63, s70
    s_lshl_b32 s63, s63, 3
    s_add_u32 s63, s63, s35
    s_lshl_b32 s63, s63, 10
    s_add_u32 s63, s63, 1048576
    v_lshlrev_b32 v15, 4, v1
    v_mov_b32 v199, s32
    s_waitcnt lgkmcnt(6)
    v_add_f32 v196, v48, v52
    v_add_f32 v197, v49, v53
    v_add_f32 v198, v50, v54
    s_waitcnt lgkmcnt(0)
    v_add_f32 v56, v56, v60
    v_add_f32 v57, v57, v61
    v_add_f32 v58, v58, v62
    v_add_f32 v196, v196, v56
    v_add_f32 v197, v197, v57
    v_add_f32 v198, v198, v58
    buffer_store_dwordx4 v[196:199], v15, s[40:43], s63 offen sc1
    s_mov_b64 exec, 1
    ds_add_u32 v178, v19 offset:24
    s_mov_b64 exec, -1
Lfn_112:
    s_mov_b64 exec, 1
    ds_write_b32 v18, v19 offset:128
    s_mov_b64 exec, -1
    s_endpgm
Lhelper:
    s_sub_u32 s33, s33, 4
    s_lshl_b32 s62, s33, 2
    s_add_u32 s62, s62, 162432
    v_mov_b32 v2, s62
    v_mov_b32 v3, 1
    v_mov_b32 v9, 162432
    s_cmp_eq_u32 s33, 0
    s_cbranch_scc0 Lzf_113
    v_lshlrev_b32 v6, 2, v1
    v_add_u32 v6, 162432, v6
    v_mov_b32 v7, 0
    ds_write_b32 v6, v7
Lzf_113:
    s_waitcnt lgkmcnt(0)
    s_mov_b32 s40, s30
    s_and_b32 s41, s31, 0xffff
    s_mov_b32 s42, 8388608
    s_mov_b32 s43, 0x20000
    s_load_dword s32, s[30:31], 0
    s_cmp_eq_u32 s33, 0
    s_cbranch_scc0 Lzc_114
    s_cmp_eq_u32 s35, 0
    s_cbranch_scc0 Lzc_114
    s_lshl_b32 s62, s34, 7
    s_add_u32 s62, s62, 229376
    v_mov_b32 v6, 0
    v_mov_b32 v7, 0
    s_mov_b64 exec, 1
    buffer_store_dword v7, v6, s[40:43], s62 offen sc1
    s_mov_b64 exec, -1
Lzc_114:
    s_mov_b32 s67, 0
    s_cmp_lt_u32 s35, 3
    s_cbranch_scc1 Lrq_115
    s_cmp_lt_u32 s35, 5
    s_cbranch_scc0 Lm7_118
    s_lshl_b32 s68, s34, 1
    s_add_u32 s68, s68, s35
    s_sub_u32 s68, s68, 3
    s_cmp_lt_u32 s34, 28
    s_cbranch_scc1 Lrm_116
    s_branch Lrr_117
Lm7_118:
    s_add_u32 s68, s34, 56
    s_cmp_eq_u32 s35, 7
    s_cbranch_scc0 Lrr_117
    s_cmp_lt_u32 s34, 4
    s_cbranch_scc1 Lrm_116
    s_branch Lrr_117
Lrq_115:
    s_mov_b32 s67, 1
    s_mov_b32 s36, s10
    s_and_b32 s37, s11, 0xffff
    s_mov_b32 s38, 7864320
    s_mov_b32 s39, 0x20000
    s_mov_b32 s44, s4
    s_and_b32 s45, s5, 0xffff
    s_mov_b32 s46, 5120
    s_mov_b32 s47, 0x20000
    s_mov_b32 s60, 12288
    s_mul_i32 s68, s34, 3
    s_add_u32 s68, s68, s35
    s_lshl_b32 s64, s68, 8
    s_add_u32 s64, s64, 65536
    s_mov_b32 s65, 24576
    s_branch Lrc_119
Lrm_116:
    s_mov_b32 s67, 2
    s_mov_b32 s36, s24
    s_and_b32 s37, s25, 0xffff
    s_mov_b32 s38, 4915200
    s_mov_b32 s39, 0x20000
    s_mov_b32 s44, s22
    s_and_b32 s45, s23, 0xffff
    s_mov_b32 s46, 5120
    s_mov_b32 s47, 0x20000
    s_mov_b32 s60, 7680
    s_lshl_b32 s64, s68, 8
    s_add_u32 s64, s64, 4096
    s_mov_b32 s65, 15360
Lrc_119:
    s_mul_i32 s62, s33, 1280
    v_lshlrev_b32 v6, 2, v1
    buffer_load_dword v10, v6, s[44:47], s62 offen offset:0
    buffer_load_dword v11, v6, s[44:47], s62 offen offset:256
    buffer_load_dword v12, v6, s[44:47], s62 offen offset:512
    buffer_load_dword v13, v6, s[44:47], s62 offen offset:768
    buffer_load_dword v14, v6, s[44:47], s62 offen offset:1024
    s_mul_i32 s62, s33, 160
    v_lshrrev_b32 v4, 4, v1
    v_lshlrev_b32 v4, 3, v4
    v_add_u32 v4, s62, v4
    v_mul_lo_u32 v4, v4, s60
    v_and_b32 v7, 15, v1
    v_lshl_add_u32 v4, v7, 3, v4
    s_lshl_b32 s62, s68, 7
    v_add_u32 v4, s62, v4
    s_mov_b32 s61, 0
    buffer_load_dwordx2 v[116:117], v4, s[36:39], s61 offen nt
    s_add_u32 s61, s61, s60
    buffer_load_dwordx2 v[118:119], v4, s[36:39], s61 offen nt
    s_add_u32 s61, s61, s60
    buffer_load_dwordx2 v[120:121], v4, s[36:39], s61 offen nt
    s_add_u32 s61, s61, s60
    buffer_load_dwordx2 v[122:123], v4, s[36:39], s61 offen nt
    s_add_u32 s61, s61, s60
    buffer_load_dwordx2 v[124:125], v4, s[36:39], s61 offen nt
    s_add_u32 s61, s61, s60
    buffer_load_dwordx2 v[126:127], v4, s[36:39], s61 offen nt
    s_add_u32 s61, s61, s60
    buffer_load_dwordx2 v[128:129], v4, s[36:39], s61 offen nt
    s_add_u32 s61, s61, s60
    buffer_load_dwordx2 v[130:131], v4, s[36:39], s61 offen nt
    s_mul_i32 s62, s60, 25
    s_add_u32 s61, s61, s62
    buffer_load_dwordx2 v[132:133], v4, s[36:39], s61 offen nt
    s_add_u32 s61, s61, s60
    buffer_load_dwordx2 v[134:135], v4, s[36:39], s61 offen nt
    s_add_u32 s61, s61, s60
    buffer_load_dwordx2 v[136:137], v4, s[36:39], s61 offen nt
    s_add_u32 s61, s61, s60
    buffer_load_dwordx2 v[138:139], v4, s[36:39], s61 offen nt
    s_add_u32 s61, s61, s60
    buffer_load_dwordx2 v[140:141], v4, s[36:39], s61 offen nt
    s_add_u32 s61, s61, s60
    buffer_load_dwordx2 v[142:143], v4, s[36:39], s61 offen nt
    s_add_u32 s61, s61, s60
    buffer_load_dwordx2 v[144:145], v4, s[36:39], s61 offen nt
    s_add_u32 s61, s61, s60
    buffer_load_dwordx2 v[146:147], v4, s[36:39], s61 offen nt
    s_mul_i32 s62, s60, 25
    s_add_u32 s61, s61, s62
    buffer_load_dwordx2 v[148:149], v4, s[36:39], s61 offen nt
    s_add_u32 s61, s61, s60
    buffer_load_dwordx2 v[150:151], v4, s[36:39], s61 offen nt
    s_add_u32 s61, s61, s60
    buffer_load_dwordx2 v[152:153], v4, s[36:39], s61 offen nt
    s_add_u32 s61, s61, s60
    buffer_load_dwordx2 v[154:155], v4, s[36:39], s61 offen nt
    s_add_u32 s61, s61, s60
    buffer_load_dwordx2 v[156:157], v4, s[36:39], s61 offen nt
    s_add_u32 s61, s61, s60
    buffer_load_dwordx2 v[158:159], v4, s[36:39], s61 offen nt
    s_add_u32 s61, s61, s60
    buffer_load_dwordx2 v[160:161], v4, s[36:39], s61 offen nt
    s_add_u32 s61, s61, s60
    buffer_load_dwordx2 v[162:163], v4, s[36:39], s61 offen nt
    s_mul_i32 s62, s60, 25
    s_add_u32 s61, s61, s62
    buffer_load_dwordx2 v[164:165], v4, s[36:39], s61 offen nt
    s_add_u32 s61, s61, s60
    buffer_load_dwordx2 v[166:167], v4, s[36:39], s61 offen nt
    s_add_u32 s61, s61, s60
    buffer_load_dwordx2 v[168:169], v4, s[36:39], s61 offen nt
    s_add_u32 s61, s61, s60
    buffer_load_dwordx2 v[170:171], v4, s[36:39], s61 offen nt
    s_add_u32 s61, s61, s60
    buffer_load_dwordx2 v[172:173], v4, s[36:39], s61 offen nt
    s_add_u32 s61, s61, s60
    buffer_load_dwordx2 v[174:175], v4, s[36:39], s61 offen nt
    s_add_u32 s61, s61, s60
    buffer_load_dwordx2 v[176:177], v4, s[36:39], s61 offen nt
    s_add_u32 s61, s61, s60
    buffer_load_dwordx2 v[178:179], v4, s[36:39], s61 offen nt
    s_mul_i32 s62, s60, 25
    s_add_u32 s61, s61, s62
    buffer_load_dwordx2 v[180:181], v4, s[36:39], s61 offen nt
    s_add_u32 s61, s61, s60
    buffer_load_dwordx2 v[182:183], v4, s[36:39], s61 offen nt
    s_add_u32 s61, s61, s60
    buffer_load_dwordx2 v[184:185], v4, s[36:39], s61 offen nt
    s_add_u32 s61, s61, s60
    buffer_load_dwordx2 v[186:187], v4, s[36:39], s61 offen nt
    s_add_u32 s61, s61, s60
    buffer_load_dwordx2 v[188:189], v4, s[36:39], s61 offen nt
    s_add_u32 s61, s61, s60
    buffer_load_dwordx2 v[190:191], v4, s[36:39], s61 offen nt
    s_add_u32 s61, s61, s60
    buffer_load_dwordx2 v[192:193], v4, s[36:39], s61 offen nt
    s_add_u32 s61, s61, s60
    buffer_load_dwordx2 v[194:195], v4, s[36:39], s61 offen nt
Lrr_117:
    s_barrier
Lnb_120:
    s_waitcnt lgkmcnt(0)
    s_add_u32 s32, s32, 0x9e3779b9
    v_and_b32 v6, 15, v1
    v_lshrrev_b32 v6, 2, v6
    v_mul_u32_u24 v6, 1280, v6
    v_lshrrev_b32 v7, 4, v1
    v_lshl_add_u32 v6, v7, 4, v6
    s_mul_i32 s62, s33, 320
    s_add_u32 s62, s62, 155648
    v_add_u32 v5, s62, v6
    s_mul_i32 s62, s33, 1280
    s_add_u32 s62, s62, 155648
    v_lshlrev_b32 v6, 2, v1
    v_add_u32 v8, s62, v6
    v_mov_b32 v26, v8
    s_cmp_eq_u32 s67, 1
    s_cbranch_scc1 Lq2_121
    s_cmp_eq_u32 s67, 2
    s_cbranch_scc1 Lm2_122
    s_branch Lpq_123
Lm2_122:
    s_waitcnt vmcnt(40)
    s_mov_b32 s91, 0x207
    v_lshlrev_b32 v16, 16, v10
    v_and_b32 v17, 0xffff0000, v10
    v_mul_f32 v28, 0xbfb8aa3b, v16
    v_exp_f32 v28, v28
    s_nop 0
    v_add_f32 v28, 1.0, v28
    v_rcp_f32 v29, v28
    s_nop 0
    v_mul_f32 v30, v16, v29
    v_fma_f32 v31, -v30, v28, v16
    v_cmp_class_f32 vcc, v31, s91
    v_fma_f32 v16, v31, v29, v30
    s_nop 0
    v_cndmask_b32 v16, v16, v30, vcc
    v_mul_f32 v28, 0xbfb8aa3b, v17
    v_exp_f32 v28, v28
    s_nop 0
    v_add_f32 v28, 1.0, v28
    v_rcp_f32 v29, v28
    s_nop 0
    v_mul_f32 v30, v17, v29
    v_fma_f32 v31, -v30, v28, v17
    v_cmp_class_f32 vcc, v31, s91
    v_fma_f32 v17, v31, v29, v30
    s_nop 0
    v_cndmask_b32 v17, v17, v30, vcc
    v_cvt_pk_bf16_f32 v28, v16, v17
    ds_write_b32 v26, v28 offset:0
    v_lshlrev_b32 v16, 16, v11
    v_and_b32 v17, 0xffff0000, v11
    v_mul_f32 v28, 0xbfb8aa3b, v16
    v_exp_f32 v28, v28
    s_nop 0
    v_add_f32 v28, 1.0, v28
    v_rcp_f32 v29, v28
    s_nop 0
    v_mul_f32 v30, v16, v29
    v_fma_f32 v31, -v30, v28, v16
    v_cmp_class_f32 vcc, v31, s91
    v_fma_f32 v16, v31, v29, v30
    s_nop 0
    v_cndmask_b32 v16, v16, v30, vcc
    v_mul_f32 v28, 0xbfb8aa3b, v17
    v_exp_f32 v28, v28
    s_nop 0
    v_add_f32 v28, 1.0, v28
    v_rcp_f32 v29, v28
    s_nop 0
    v_mul_f32 v30, v17, v29
    v_fma_f32 v31, -v30, v28, v17
    v_cmp_class_f32 vcc, v31, s91
    v_fma_f32 v17, v31, v29, v30
    s_nop 0
    v_cndmask_b32 v17, v17, v30, vcc
    v_cvt_pk_bf16_f32 v28, v16, v17
    ds_write_b32 v26, v28 offset:256
    v_lshlrev_b32 v16, 16, v12
    v_and_b32 v17, 0xffff0000, v12
    v_mul_f32 v28, 0xbfb8aa3b, v16
    v_exp_f32 v28, v28
    s_nop 0
    v_add_f32 v28, 1.0, v28
    v_rcp_f32 v29, v28
    s_nop 0
    v_mul_f32 v30, v16, v29
    v_fma_f32 v31, -v30, v28, v16
    v_cmp_class_f32 vcc, v31, s91
    v_fma_f32 v16, v31, v29, v30
    s_nop 0
    v_cndmask_b32 v16, v16, v30, vcc
    v_mul_f32 v28, 0xbfb8aa3b, v17
    v_exp_f32 v28, v28
    s_nop 0
    v_add_f32 v28, 1.0, v28
    v_rcp_f32 v29, v28
    s_nop 0
    v_mul_f32 v30, v17, v29
    v_fma_f32 v31, -v30, v28, v17
    v_cmp_class_f32 vcc, v31, s91
    v_fma_f32 v17, v31, v29, v30
    s_nop 0
    v_cndmask_b32 v17, v17, v30, vcc
    v_cvt_pk_bf16_f32 v28, v16, v17
    ds_write_b32 v26, v28 offset:512
    v_lshlrev_b32 v16, 16, v13
    v_and_b32 v17, 0xffff0000, v13
    v_mul_f32 v28, 0xbfb8aa3b, v16
    v_exp_f32 v28, v28
    s_nop 0
    v_add_f32 v28, 1.0, v28
    v_rcp_f32 v29, v28
    s_nop 0
    v_mul_f32 v30, v16, v29
    v_fma_f32 v31, -v30, v28, v16
    v_cmp_class_f32 vcc, v31, s91
    v_fma_f32 v16, v31, v29, v30
    s_nop 0
    v_cndmask_b32 v16, v16, v30, vcc
    v_mul_f32 v28, 0xbfb8aa3b, v17
    v_exp_f32 v28, v28
    s_nop 0
    v_add_f32 v28, 1.0, v28
    v_rcp_f32 v29, v28
    s_nop 0
    v_mul_f32 v30, v17, v29
    v_fma_f32 v31, -v30, v28, v17
    v_cmp_class_f32 vcc, v31, s91
    v_fma_f32 v17, v31, v29, v30
    s_nop 0
    v_cndmask_b32 v17, v17, v30, vcc
    v_cvt_pk_bf16_f32 v28, v16, v17
    ds_write_b32 v26, v28 offset:768
    v_lshlrev_b32 v16, 16, v14
    v_and_b32 v17, 0xffff0000, v14
    v_mul_f32 v28, 0xbfb8aa3b, v16
    v_exp_f32 v28, v28
    s_nop 0
    v_add_f32 v28, 1.0, v28
    v_rcp_f32 v29, v28
    s_nop 0
    v_mul_f32 v30, v16, v29
    v_fma_f32 v31, -v30, v28, v16
    v_cmp_class_f32 vcc, v31, s91
    v_fma_f32 v16, v31, v29, v30
    s_nop 0
    v_cndmask_b32 v16, v16, v30, vcc
    v_mul_f32 v28, 0xbfb8aa3b, v17
    v_exp_f32 v28, v28
    s_nop 0
    v_add_f32 v28, 1.0, v28
    v_rcp_f32 v29, v28
    s_nop 0
    v_mul_f32 v30, v17, v29
    v_fma_f32 v31, -v30, v28, v17
    v_cmp_class_f32 vcc, v31, s91
    v_fma_f32 v17, v31, v29, v30
    s_nop 0
    v_cndmask_b32 v17, v17, v30, vcc
    v_cvt_pk_bf16_f32 v28, v16, v17
    ds_write_b32 v26, v28 offset:1024
    s_mov_b64 exec, 1
    ds_add_u32 v9, v3 offset:0
    s_mov_b64 exec, -1
Lw_124:
    ds_read_b32 v8, v9 offset:0
    s_waitcnt lgkmcnt(0)
    v_readfirstlane_b32 s90, v8
    s_nop 0
    s_cmp_ge_u32 s90, 4
    s_cbranch_scc1 Lwd_125
    s_sub_u32 s96, s96, 1
    s_cbranch_scc1 Labort
    s_branch Lw_124
Lwd_125:
    s_waitcnt vmcnt(0)
    v_perm_b32 v100, v118, v116, s97
    v_perm_b32 v101, v122, v120, s97
    v_perm_b32 v102, v126, v124, s97
    v_perm_b32 v103, v130, v128, s97
    v_perm_b32 v104, v118, v116, s98
    v_perm_b32 v105, v122, v120, s98
    v_perm_b32 v106, v126, v124, s98
    v_perm_b32 v107, v130, v128, s98
    v_perm_b32 v108, v119, v117, s97
    v_perm_b32 v109, v123, v121, s97
    v_perm_b32 v110, v127, v125, s97
    v_perm_b32 v111, v131, v129, s97
    v_perm_b32 v112, v119, v117, s98
    v_perm_b32 v113, v123, v121, s98
    v_perm_b32 v114, v127, v125, s98
    v_perm_b32 v115, v131, v129, s98
    v_perm_b32 v116, v134, v132, s97
    v_perm_b32 v117, v138, v136, s97
    v_perm_b32 v118, v142, v140, s97
    v_perm_b32 v119, v146, v144, s97
    v_perm_b32 v120, v134, v132, s98
    v_perm_b32 v121, v138, v136, s98
    v_perm_b32 v122, v142, v140, s98
    v_perm_b32 v123, v146, v144, s98
    v_perm_b32 v124, v135, v133, s97
    v_perm_b32 v125, v139, v137, s97
    v_perm_b32 v126, v143, v141, s97
    v_perm_b32 v127, v147, v145, s97
    v_perm_b32 v128, v135, v133, s98
    v_perm_b32 v129, v139, v137, s98
    v_perm_b32 v130, v143, v141, s98
    v_perm_b32 v131, v147, v145, s98
    v_perm_b32 v132, v150, v148, s97
    v_perm_b32 v133, v154, v152, s97
    v_perm_b32 v134, v158, v156, s97
    v_perm_b32 v135, v162, v160, s97
    v_perm_b32 v136, v150, v148, s98
    v_perm_b32 v137, v154, v152, s98
    v_perm_b32 v138, v158, v156, s98
    v_perm_b32 v139, v162, v160, s98
    v_perm_b32 v140, v151, v149, s97
    v_perm_b32 v141, v155, v153, s97
    v_perm_b32 v142, v159, v157, s97
    v_perm_b32 v143, v163, v161, s97
    v_perm_b32 v144, v151, v149, s98
    v_perm_b32 v145, v155, v153, s98
    v_perm_b32 v146, v159, v157, s98
    v_perm_b32 v147, v163, v161, s98
    v_perm_b32 v148, v166, v164, s97
    v_perm_b32 v149, v170, v168, s97
    v_perm_b32 v150, v174, v172, s97
    v_perm_b32 v151, v178, v176, s97
    v_perm_b32 v152, v166, v164, s98
    v_perm_b32 v153, v170, v168, s98
    v_perm_b32 v154, v174, v172, s98
    v_perm_b32 v155, v178, v176, s98
    v_perm_b32 v156, v167, v165, s97
    v_perm_b32 v157, v171, v169, s97
    v_perm_b32 v158, v175, v173, s97
    v_perm_b32 v159, v179, v177, s97
    v_perm_b32 v160, v167, v165, s98
    v_perm_b32 v161, v171, v169, s98
    v_perm_b32 v162, v175, v173, s98
    v_perm_b32 v163, v179, v177, s98
    v_perm_b32 v164, v182, v180, s97
    v_perm_b32 v165, v186, v184, s97
    v_perm_b32 v166, v190, v188, s97
    v_perm_b32 v167, v194, v192, s97
    v_perm_b32 v168, v182, v180, s98
    v_perm_b32 v169, v186, v184, s98
    v_perm_b32 v170, v190, v188, s98
    v_perm_b32 v171, v194, v192, s98
    v_perm_b32 v172, v183, v181, s97
    v_perm_b32 v173, v187, v185, s97
    v_perm_b32 v174, v191, v189, s97
    v_perm_b32 v175, v195, v193, s97
    v_perm_b32 v176, v183, v181, s98
    v_perm_b32 v177, v187, v185, s98
    v_perm_b32 v178, v191, v189, s98
    v_perm_b32 v179, v195, v193, s98
    ds_read_b128 v[200:203], v5 offset:0
    ds_read_b128 v[204:207], v5 offset:64
    ds_read_b128 v[208:211], v5 offset:128
    ds_read_b128 v[212:215], v5 offset:192
    ds_read_b128 v[216:219], v5 offset:256
    s_waitcnt lgkmcnt(4)
    v_mfma_f32_16x16x32_bf16 v[220:223], v[200:203], v[100:103], 0
    v_mfma_f32_16x16x32_bf16 v[224:227], v[200:203], v[104:107], 0
    v_mfma_f32_16x16x32_bf16 v[228:231], v[200:203], v[108:111], 0
    v_mfma_f32_16x16x32_bf16 v[232:235], v[200:203], v[112:115], 0
    s_waitcnt lgkmcnt(3)
    v_mfma_f32_16x16x32_bf16 v[220:223], v[204:207], v[116:119], v[220:223]
    v_mfma_f32_16x16x32_bf16 v[224:227], v[204:207], v[120:123], v[224:227]
    v_mfma_f32_16x16x32_bf16 v[228:231], v[204:207], v[124:127], v[228:231]
    v_mfma_f32_16x16x32_bf16 v[232:235], v[204:207], v[128:131], v[232:235]
    s_waitcnt lgkmcnt(2)
    v_mfma_f32_16x16x32_bf16 v[220:223], v[208:211], v[132:135], v[220:223]
    v_mfma_f32_16x16x32_bf16 v[224:227], v[208:211], v[136:139], v[224:227]
    v_mfma_f32_16x16x32_bf16 v[228:231], v[208:211], v[140:143], v[228:231]
    v_mfma_f32_16x16x32_bf16 v[232:235], v[208:211], v[144:147], v[232:235]
    s_waitcnt lgkmcnt(1)
    v_mfma_f32_16x16x32_bf16 v[220:223], v[212:215], v[148:151], v[220:223]
    v_mfma_f32_16x16x32_bf16 v[224:227], v[212:215], v[152:155], v[224:227]
    v_mfma_f32_16x16x32_bf16 v[228:231], v[212:215], v[156:159], v[228:231]
    v_mfma_f32_16x16x32_bf16 v[232:235], v[212:215], v[160:163], v[232:235]
    s_waitcnt lgkmcnt(0)
    v_mfma_f32_16x16x32_bf16 v[220:223], v[216:219], v[164:167], v[220:223]
    v_mfma_f32_16x16x32_bf16 v[224:227], v[216:219], v[168:171], v[224:227]
    v_mfma_f32_16x16x32_bf16 v[228:231], v[216:219], v[172:175], v[228:231]
    v_mfma_f32_16x16x32_bf16 v[232:235], v[216:219], v[176:179], v[232:235]
    s_nop 7
    s_nop 1
    v_mov_b32 v200, v220
    v_mov_b32 v201, v224
    v_mov_b32 v202, v228
    v_mov_b32 v203, v232
    s_lshl_b32 s62, s33, 10
    s_add_u32 s62, s62, 147456
    v_lshlrev_b32 v6, 4, v1
    v_add_u32 v7, s62, v6
    ds_write_b128 v7, v[200:203]
    s_mov_b64 exec, 1
    ds_add_u32 v9, v3 offset:4
    s_mov_b64 exec, -1
Lw_126:
    ds_read_b32 v8, v9 offset:4
    s_waitcnt lgkmcnt(0)
    v_readfirstlane_b32 s90, v8
    s_nop 0
    s_cmp_ge_u32 s90, 4
    s_cbranch_scc1 Lwd_127
    s_sub_u32 s96, s96, 1
    s_cbranch_scc1 Labort
    s_branch Lw_126
Lwd_127:
    s_cmp_eq_u32 s33, 0
    s_cbranch_scc0 Lgf_128
    v_add_u32 v7, 147456, v6
    ds_read_b128 v[200:203], v7 offset:0
    ds_read_b128 v[204:207], v7 offset:1024
    ds_read_b128 v[208:211], v7 offset:2048
    ds_read_b128 v[212:215], v7 offset:3072
    s_waitcnt lgkmcnt(0)
    v_add_f32 v200, v200, v204
    v_add_f32 v208, v208, v212
    v_add_f32 v201, v201, v205
    v_add_f32 v209, v209, v213
    v_add_f32 v202, v202, v206
    v_add_f32 v210, v210, v214
    v_add_f32 v203, v203, v207
    v_add_f32 v211, v211, v215
    v_add_f32 v200, v200, v208
    v_add_f32 v201, v201, v209
    v_add_f32 v202, v202, v210
    v_add_f32 v203, v203, v211
    v_cvt_pk_bf16_f32 v204, v200, v201
    v_cvt_pk_bf16_f32 v206, v202, v203
    v_mov_b32 v205, s32
    v_mov_b32 v207, s32
    v_lshrrev_b32 v6, 4, v1
    v_mul_lo_u32 v6, v6, s65
    v_and_b32 v7, 15, v1
    v_lshl_add_u32 v6, v7, 4, v6
    buffer_store_dwordx4 v[204:207], v6, s[40:43], s64 offen sc1
Lgf_128:
    s_branch Lpq_123
Lq2_121:
    s_waitcnt vmcnt(40)
    v_lshlrev_b32 v16, 16, v10
    v_and_b32 v17, 0xffff0000, v10
    v_lshlrev_b32 v18, 16, v11
    v_and_b32 v19, 0xffff0000, v11
    v_lshlrev_b32 v20, 16, v12
    v_and_b32 v21, 0xffff0000, v12
    v_lshlrev_b32 v22, 16, v13
    v_and_b32 v23, 0xffff0000, v13
    v_lshlrev_b32 v24, 16, v14
    v_and_b32 v25, 0xffff0000, v14
    s_nop 0
    v_readfirstlane_b32 s90, v16
    s_nop 0
    s_mov_b32 s91, s90
    v_pk_add_f32 v[80:81], v[16:17], s[90:91] neg_lo:[0,1] neg_hi:[0,1]
    v_pk_add_f32 v[82:83], v[18:19], s[90:91] neg_lo:[0,1] neg_hi:[0,1]
    v_pk_add_f32 v[84:85], v[20:21], s[90:91] neg_lo:[0,1] neg_hi:[0,1]
    v_pk_add_f32 v[86:87], v[22:23], s[90:91] neg_lo:[0,1] neg_hi:[0,1]
    v_pk_add_f32 v[88:89], v[24:25], s[90:91] neg_lo:[0,1] neg_hi:[0,1]
    v_pk_mul_f32 v[30:31], v[80:81], v[80:81]
    v_pk_add_f32 v[28:29], v[80:81], v[82:83]
    v_pk_fma_f32 v[30:31], v[82:83], v[82:83], v[30:31]
    v_pk_add_f32 v[28:29], v[28:29], v[84:85]
    v_pk_fma_f32 v[30:31], v[84:85], v[84:85], v[30:31]
    v_pk_add_f32 v[28:29], v[28:29], v[86:87]
    v_pk_fma_f32 v[30:31], v[86:87], v[86:87], v[30:31]
    v_pk_add_f32 v[28:29], v[28:29], v[88:89]
    v_pk_fma_f32 v[30:31], v[88:89], v[88:89], v[30:31]
    v_add_f32 v28, v28, v29
    v_add_f32 v30, v30, v31
    s_nop 0
    v_add_f32_dpp v28, v28, v28 row_ror:8 row_mask:0xf bank_mask:0xf
    v_add_f32_dpp v30, v30, v30 row_ror:8 row_mask:0xf bank_mask:0xf
    s_nop 0
    v_add_f32_dpp v28, v28, v28 row_ror:4 row_mask:0xf bank_mask:0xf
    v_add_f32_dpp v30, v30, v30 row_ror:4 row_mask:0xf bank_mask:0xf
    s_nop 0
    v_add_f32_dpp v28, v28, v28 row_ror:2 row_mask:0xf bank_mask:0xf
    v_add_f32_dpp v30, v30, v30 row_ror:2 row_mask:0xf bank_mask:0xf
    s_nop 0
    v_add_f32_dpp v28, v28, v28 row_ror:1 row_mask:0xf bank_mask:0xf
    v_add_f32_dpp v30, v30, v30 row_ror:1 row_mask:0xf bank_mask:0xf
    v_mov_b32 v29, v28
    v_mov_b32 v31, v30
    s_nop 1
    v_permlane16_swap_b32 v29, v28
    v_permlane16_swap_b32 v31, v30
    v_add_f32 v28, v29, v28
    v_add_f32 v30, v31, v30
    v_mov_b32 v29, v28
    v_mov_b32 v31, v30
    s_nop 1
    v_permlane32_swap_b32 v29, v28
    v_permlane32_swap_b32 v31, v30
    v_add_f32 v28, v29, v28
    v_add_f32 v30, v31, v30
    v_mul_f32 v28, 0x3acccccd, v28
    v_mul_f32 v30, 0x3acccccd, v30
    v_fma_f32 v30, -v28, v28, v30
    v_add_f32 v28, s90, v28
    v_max_f32 v30, 0, v30
    v_cvt_pk_bf16_f32 v29, v28, v30
    v_lshlrev_b32 v28, 16, v29
    v_and_b32 v30, 0xffff0000, v29
    v_add_f32 v30, 0x3727c5ac, v30
    v_cvt_pk_bf16_f32 v31, v30, v30
    v_lshlrev_b32 v30, 16, v31
    v_sqrt_f32 v30, v30
    v_pk_add_f32 v[16:17], v[16:17], v[28:29] op_sel_hi:[1,0] neg_lo:[0,1] neg_hi:[0,1]
    v_pk_add_f32 v[18:19], v[18:19], v[28:29] op_sel_hi:[1,0] neg_lo:[0,1] neg_hi:[0,1]
    v_pk_add_f32 v[20:21], v[20:21], v[28:29] op_sel_hi:[1,0] neg_lo:[0,1] neg_hi:[0,1]
    v_pk_add_f32 v[22:23], v[22:23], v[28:29] op_sel_hi:[1,0] neg_lo:[0,1] neg_hi:[0,1]
    v_pk_add_f32 v[24:25], v[24:25], v[28:29] op_sel_hi:[1,0] neg_lo:[0,1] neg_hi:[0,1]
    v_cvt_pk_bf16_f32 v31, v30, v30
    v_lshlrev_b32 v30, 16, v31
    v_rcp_f32 v30, v30
    v_cvt_pk_bf16_f32 v80, v16, v17
    v_cvt_pk_bf16_f32 v81, v18, v19
    v_cvt_pk_bf16_f32 v82, v20, v21
    v_cvt_pk_bf16_f32 v83, v22, v23
    v_cvt_pk_bf16_f32 v84, v24, v25
    v_lshlrev_b32 v16, 16, v80
    v_and_b32 v17, 0xffff0000, v80
    v_lshlrev_b32 v18, 16, v81
    v_and_b32 v19, 0xffff0000, v81
    v_lshlrev_b32 v20, 16, v82
    v_and_b32 v21, 0xffff0000, v82
    v_lshlrev_b32 v22, 16, v83
    v_and_b32 v23, 0xffff0000, v83
    v_lshlrev_b32 v24, 16, v84
    v_and_b32 v25, 0xffff0000, v84
    v_pk_mul_f32 v[16:17], v[16:17], v[30:31] op_sel_hi:[1,0]
    v_pk_mul_f32 v[18:19], v[18:19], v[30:31] op_sel_hi:[1,0]
    v_pk_mul_f32 v[20:21], v[20:21], v[30:31] op_sel_hi:[1,0]
    v_pk_mul_f32 v[22:23], v[22:23], v[30:31] op_sel_hi:[1,0]
    v_pk_mul_f32 v[24:25], v[24:25], v[30:31] op_sel_hi:[1,0]
    v_cvt_pk_bf16_f32 v80, v16, v17
    v_cvt_pk_bf16_f32 v81, v18, v19
    v_cvt_pk_bf16_f32 v82, v20, v21
    v_cvt_pk_bf16_f32 v83, v22, v23
    v_cvt_pk_bf16_f32 v84, v24, v25
    v_lshlrev_b32 v16, 16, v80
    v_and_b32 v17, 0xffff0000, v80
    v_lshlrev_b32 v18, 16, v81
    v_and_b32 v19, 0xffff0000, v81
    v_lshlrev_b32 v20, 16, v82
    v_and_b32 v21, 0xffff0000, v82
    v_lshlrev_b32 v22, 16, v83
    v_and_b32 v23, 0xffff0000, v83
    v_lshlrev_b32 v24, 16, v84
    v_and_b32 v25, 0xffff0000, v84
    s_waitcnt vmcnt(0)
    v_perm_b32 v100, v118, v116, s97
    v_perm_b32 v101, v122, v120, s97
    v_perm_b32 v102, v126, v124, s97
    v_perm_b32 v103, v130, v128, s97
    v_perm_b32 v104, v118, v116, s98
    v_perm_b32 v105, v122, v120, s98
    v_perm_b32 v106, v126, v124, s98
    v_perm_b32 v107, v130, v128, s98
    v_perm_b32 v108, v119, v117, s97
    v_perm_b32 v109, v123, v121, s97
    v_perm_b32 v110, v127, v125, s97
    v_perm_b32 v111, v131, v129, s97
    v_perm_b32 v112, v119, v117, s98
    v_perm_b32 v113, v123, v121, s98
    v_perm_b32 v114, v127, v125, s98
    v_perm_b32 v115, v131, v129, s98
    v_perm_b32 v116, v134, v132, s97
    v_perm_b32 v117, v138, v136, s97
    v_perm_b32 v118, v142, v140, s97
    v_perm_b32 v119, v146, v144, s97
    v_perm_b32 v120, v134, v132, s98
    v_perm_b32 v121, v138, v136, s98
    v_perm_b32 v122, v142, v140, s98
    v_perm_b32 v123, v146, v144, s98
    v_perm_b32 v124, v135, v133, s97
    v_perm_b32 v125, v139, v137, s97
    v_perm_b32 v126, v143, v141, s97
    v_perm_b32 v127, v147, v145, s97
    v_perm_b32 v128, v135, v133, s98
    v_perm_b32 v129, v139, v137, s98
    v_perm_b32 v130, v143, v141, s98
    v_perm_b32 v131, v147, v145, s98
    v_perm_b32 v132, v150, v148, s97
    v_perm_b32 v133, v154, v152, s97
    v_perm_b32 v134, v158, v156, s97
    v_perm_b32 v135, v162, v160, s97
    v_perm_b32 v136, v150, v148, s98
    v_perm_b32 v137, v154, v152, s98
    v_perm_b32 v138, v158, v156, s98
    v_perm_b32 v139, v162, v160, s98
    v_perm_b32 v140, v151, v149, s97
    v_perm_b32 v141, v155, v153, s97
    v_perm_b32 v142, v159, v157, s97
    v_perm_b32 v143, v163, v161, s97
    v_perm_b32 v144, v151, v149, s98
    v_perm_b32 v145, v155, v153, s98
    v_perm_b32 v146, v159, v157, s98
    v_perm_b32 v147, v163, v161, s98
    v_perm_b32 v148, v166, v164, s97
    v_perm_b32 v149, v170, v168, s97
    v_perm_b32 v150, v174, v172, s97
    v_perm_b32 v151, v178, v176, s97
    v_perm_b32 v152, v166, v164, s98
    v_perm_b32 v153, v170, v168, s98
    v_perm_b32 v154, v174, v172, s98
    v_perm_b32 v155, v178, v176, s98
    v_perm_b32 v156, v167, v165, s97
    v_perm_b32 v157, v171, v169, s97
    v_perm_b32 v158, v175, v173, s97
    v_perm_b32 v159, v179, v177, s97
    v_perm_b32 v160, v167, v165, s98
    v_perm_b32 v161, v171, v169, s98
    v_perm_b32 v162, v175, v173, s98
    v_perm_b32 v163, v179, v177, s98
    v_perm_b32 v164, v182, v180, s97
    v_perm_b32 v165, v186, v184, s97
    v_perm_b32 v166, v190, v188, s97
    v_perm_b32 v167, v194, v192, s97
    v_perm_b32 v168, v182, v180, s98
    v_perm_b32 v169, v186, v184, s98
    v_perm_b32 v170, v190, v188, s98
    v_perm_b32 v171, v194, v192, s98
    v_perm_b32 v172, v183, v181, s97
    v_perm_b32 v173, v187, v185, s97
    v_perm_b32 v174, v191, v189, s97
    v_perm_b32 v175, v195, v193, s97
    v_perm_b32 v176, v183, v181, s98
    v_perm_b32 v177, v187, v185, s98
    v_perm_b32 v178, v191, v189, s98
    v_perm_b32 v179, v195, v193, s98
    s_mul_i32 s62, s33, 15360
    s_add_u32 s62, s62, 4096
    s_add_u32 s63, s62, 2560
    v_lshlrev_b32 v6, 3, v1
    s_branch Lpoll_129
Lpollr_130:
    s_sub_u32 s96, s96, 1
    s_cbranch_scc1 Labort
Lpoll_129:
    buffer_load_dwordx2 v[32:33], v6, s[40:43], s62 offen offset:0 sc1
    buffer_load_dwordx2 v[34:35], v6, s[40:43], s62 offen offset:512 sc1
    buffer_load_dwordx2 v[36:37], v6, s[40:43], s62 offen offset:1024 sc1
    buffer_load_dwordx2 v[38:39], v6, s[40:43], s62 offen offset:1536 sc1
    buffer_load_dwordx2 v[40:41], v6, s[40:43], s62 offen offset:2048 sc1
    buffer_load_dwordx2 v[42:43], v6, s[40:43], s63 offen offset:0 sc1
    buffer_load_dwordx2 v[44:45], v6, s[40:43], s63 offen offset:512 sc1
    buffer_load_dwordx2 v[46:47], v6, s[40:43], s63 offen offset:1024 sc1
    buffer_load_dwordx2 v[48:49], v6, s[40:43], s63 offen offset:1536 sc1
    buffer_load_dwordx2 v[50:51], v6, s[40:43], s63 offen offset:2048 sc1
    s_waitcnt vmcnt(0)
    v_xor_b32 v28, s32, v33
    v_xor_b32 v29, s32, v35
    v_xor_b32 v30, s32, v37
    v_or3_b32 v28, v28, v29, v30
    v_xor_b32 v29, s32, v39
    v_xor_b32 v30, s32, v41
    v_or3_b32 v28, v28, v29, v30
    v_xor_b32 v29, s32, v43
    v_xor_b32 v30, s32, v45
    v_or3_b32 v28, v28, v29, v30
    v_xor_b32 v29, s32, v47
    v_xor_b32 v30, s32, v49
    v_or3_b32 v28, v28, v29, v30
    v_xor_b32 v29, s32, v51
    v_or_b32 v28, v28, v29
    v_cmp_ne_u32 vcc, 0, v28
    s_nop 1
    s_cbranch_vccnz Lpollr_130
Lpolld_131:
    v_lshlrev_b32 v68, 16, v32
    v_and_b32 v69, 0xffff0000, v32
    v_lshlrev_b32 v70, 16, v34
    v_and_b32 v71, 0xffff0000, v34
    v_lshlrev_b32 v72, 16, v36
    v_and_b32 v73, 0xffff0000, v36
    v_lshlrev_b32 v74, 16, v38
    v_and_b32 v75, 0xffff0000, v38
    v_lshlrev_b32 v76, 16, v40
    v_and_b32 v77, 0xffff0000, v40
    v_lshlrev_b32 v56, 16, v42
    v_and_b32 v57, 0xffff0000, v42
    v_add_f32 v56, 1.0, v56
    v_add_f32 v57, 1.0, v57
    v_cvt_pk_bf16_f32 v28, v56, v57
    v_lshlrev_b32 v56, 16, v28
    v_and_b32 v57, 0xffff0000, v28
    v_lshlrev_b32 v58, 16, v44
    v_and_b32 v59, 0xffff0000, v44
    v_add_f32 v58, 1.0, v58
    v_add_f32 v59, 1.0, v59
    v_cvt_pk_bf16_f32 v28, v58, v59
    v_lshlrev_b32 v58, 16, v28
    v_and_b32 v59, 0xffff0000, v28
    v_lshlrev_b32 v60, 16, v46
    v_and_b32 v61, 0xffff0000, v46
    v_add_f32 v60, 1.0, v60
    v_add_f32 v61, 1.0, v61
    v_cvt_pk_bf16_f32 v28, v60, v61
    v_lshlrev_b32 v60, 16, v28
    v_and_b32 v61, 0xffff0000, v28
    v_lshlrev_b32 v62, 16, v48
    v_and_b32 v63, 0xffff0000, v48
    v_add_f32 v62, 1.0, v62
    v_add_f32 v63, 1.0, v63
    v_cvt_pk_bf16_f32 v28, v62, v63
    v_lshlrev_b32 v62, 16, v28
    v_and_b32 v63, 0xffff0000, v28
    v_lshlrev_b32 v64, 16, v50
    v_and_b32 v65, 0xffff0000, v50
    v_add_f32 v64, 1.0, v64
    v_add_f32 v65, 1.0, v65
    v_cvt_pk_bf16_f32 v28, v64, v65
    v_lshlrev_b32 v64, 16, v28
    v_and_b32 v65, 0xffff0000, v28
    v_pk_mul_f32 v[16:17], v[16:17], v[56:57]
    v_pk_mul_f32 v[18:19], v[18:19], v[58:59]
    v_pk_mul_f32 v[20:21], v[20:21], v[60:61]
    v_pk_mul_f32 v[22:23], v[22:23], v[62:63]
    v_pk_mul_f32 v[24:25], v[24:25], v[64:65]
    v_cvt_pk_bf16_f32 v80, v16, v17
    v_cvt_pk_bf16_f32 v81, v18, v19
    v_cvt_pk_bf16_f32 v82, v20, v21
    v_cvt_pk_bf16_f32 v83, v22, v23
    v_cvt_pk_bf16_f32 v84, v24, v25
    v_lshlrev_b32 v16, 16, v80
    v_and_b32 v17, 0xffff0000, v80
    v_lshlrev_b32 v18, 16, v81
    v_and_b32 v19, 0xffff0000, v81
    v_lshlrev_b32 v20, 16, v82
    v_and_b32 v21, 0xffff0000, v82
    v_lshlrev_b32 v22, 16, v83
    v_and_b32 v23, 0xffff0000, v83
    v_lshlrev_b32 v24, 16, v84
    v_and_b32 v25, 0xffff0000, v84
    v_pk_add_f32 v[16:17], v[16:17], v[68:69]
    v_pk_add_f32 v[18:19], v[18:19], v[70:71]
    v_pk_add_f32 v[20:21], v[20:21], v[72:73]
    v_pk_add_f32 v[22:23], v[22:23], v[74:75]
    v_pk_add_f32 v[24:25], v[24:25], v[76:77]
    v_cvt_pk_bf16_f32 v80, v16, v17
    ds_write_b32 v26, v80 offset:0
    v_cvt_pk_bf16_f32 v81, v18, v19
    ds_write_b32 v26, v81 offset:256
    v_cvt_pk_bf16_f32 v82, v20, v21
    ds_write_b32 v26, v82 offset:512
    v_cvt_pk_bf16_f32 v83, v22, v23
    ds_write_b32 v26, v83 offset:768
    v_cvt_pk_bf16_f32 v84, v24, v25
    ds_write_b32 v26, v84 offset:1024
    s_mov_b64 exec, 1
    ds_add_u32 v9, v3 offset:0
    s_mov_b64 exec, -1
Lw_132:
    ds_read_b32 v8, v9 offset:0
    s_waitcnt lgkmcnt(0)
    v_readfirstlane_b32 s90, v8
    s_nop 0
    s_cmp_ge_u32 s90, 4
    s_cbranch_scc1 Lwd_133
    s_sub_u32 s96, s96, 1
    s_cbranch_scc1 Labort
    s_branch Lw_132
Lwd_133:
    ds_read_b128 v[200:203], v5 offset:0
    ds_read_b128 v[204:207], v5 offset:64
    ds_read_b128 v[208:211], v5 offset:128
    ds_read_b128 v[212:215], v5 offset:192
    ds_read_b128 v[216:219], v5 offset:256
    s_waitcnt lgkmcnt(4)
    v_mfma_f32_16x16x32_bf16 v[220:223], v[200:203], v[100:103], 0
    v_mfma_f32_16x16x32_bf16 v[224:227], v[200:203], v[104:107], 0
    v_mfma_f32_16x16x32_bf16 v[228:231], v[200:203], v[108:111], 0
    v_mfma_f32_16x16x32_bf16 v[232:235], v[200:203], v[112:115], 0
    s_waitcnt lgkmcnt(3)
    v_mfma_f32_16x16x32_bf16 v[220:223], v[204:207], v[116:119], v[220:223]
    v_mfma_f32_16x16x32_bf16 v[224:227], v[204:207], v[120:123], v[224:227]
    v_mfma_f32_16x16x32_bf16 v[228:231], v[204:207], v[124:127], v[228:231]
    v_mfma_f32_16x16x32_bf16 v[232:235], v[204:207], v[128:131], v[232:235]
    s_waitcnt lgkmcnt(2)
    v_mfma_f32_16x16x32_bf16 v[220:223], v[208:211], v[132:135], v[220:223]
    v_mfma_f32_16x16x32_bf16 v[224:227], v[208:211], v[136:139], v[224:227]
    v_mfma_f32_16x16x32_bf16 v[228:231], v[208:211], v[140:143], v[228:231]
    v_mfma_f32_16x16x32_bf16 v[232:235], v[208:211], v[144:147], v[232:235]
    s_waitcnt lgkmcnt(1)
    v_mfma_f32_16x16x32_bf16 v[220:223], v[212:215], v[148:151], v[220:223]
    v_mfma_f32_16x16x32_bf16 v[224:227], v[212:215], v[152:155], v[224:227]
    v_mfma_f32_16x16x32_bf16 v[228:231], v[212:215], v[156:159], v[228:231]
    v_mfma_f32_16x16x32_bf16 v[232:235], v[212:215], v[160:163], v[232:235]
    s_waitcnt lgkmcnt(0)
    v_mfma_f32_16x16x32_bf16 v[220:223], v[216:219], v[164:167], v[220:223]
    v_mfma_f32_16x16x32_bf16 v[224:227], v[216:219], v[168:171], v[224:227]
    v_mfma_f32_16x16x32_bf16 v[228:231], v[216:219], v[172:175], v[228:231]
    v_mfma_f32_16x16x32_bf16 v[232:235], v[216:219], v[176:179], v[232:235]
    s_nop 7
    s_nop 1
    v_mov_b32 v200, v220
    v_mov_b32 v201, v224
    v_mov_b32 v202, v228
    v_mov_b32 v203, v232
    s_lshl_b32 s62, s33, 10
    s_add_u32 s62, s62, 147456
    v_lshlrev_b32 v6, 4, v1
    v_add_u32 v7, s62, v6
    ds_write_b128 v7, v[200:203]
    s_mov_b64 exec, 1
    ds_add_u32 v9, v3 offset:4
    s_mov_b64 exec, -1
Lw_134:
    ds_read_b32 v8, v9 offset:4
    s_waitcnt lgkmcnt(0)
    v_readfirstlane_b32 s90, v8
    s_nop 0
    s_cmp_ge_u32 s90, 4
    s_cbranch_scc1 Lwd_135
    s_sub_u32 s96, s96, 1
    s_cbranch_scc1 Labort
    s_branch Lw_134
Lwd_135:
    s_cmp_eq_u32 s33, 0
    s_cbranch_scc0 Lgf_136
    v_add_u32 v7, 147456, v6
    ds_read_b128 v[200:203], v7 offset:0
    ds_read_b128 v[204:207], v7 offset:1024
    ds_read_b128 v[208:211], v7 offset:2048
    ds_read_b128 v[212:215], v7 offset:3072
    s_waitcnt lgkmcnt(0)
    v_add_f32 v200, v200, v204
    v_add_f32 v208, v208, v212
    v_add_f32 v201, v201, v205
    v_add_f32 v209, v209, v213
    v_add_f32 v202, v202, v206
    v_add_f32 v210, v210, v214
    v_add_f32 v203, v203, v207
    v_add_f32 v211, v211, v215
    v_add_f32 v200, v200, v208
    v_add_f32 v201, v201, v209
    v_add_f32 v202, v202, v210
    v_add_f32 v203, v203, v211
    v_cvt_pk_bf16_f32 v204, v200, v201
    v_cvt_pk_bf16_f32 v206, v202, v203
    v_mov_b32 v205, s32
    v_mov_b32 v207, s32
    v_lshrrev_b32 v6, 4, v1
    v_mul_lo_u32 v6, v6, s65
    v_and_b32 v7, 15, v1
    v_lshl_add_u32 v6, v7, 4, v6
    buffer_store_dwordx4 v[204:207], v6, s[40:43], s64 offen sc1
Lgf_136:
Lpq_123:
    s_cmp_eq_u32 s33, 0
    s_cbranch_scc0 Ljd_137
    s_waitcnt lgkmcnt(0)
    s_mov_b64 exec, 1
    ds_write_b32 v9, v3 offset:8
    s_mov_b64 exec, -1
Ljd_137:
    s_mov_b32 s69, 0
    s_mov_b32 s70, 0
    s_cmp_lt_u32 s35, 5
    s_cbranch_scc1 Lrd_143
    s_cmp_eq_u32 s35, 5
    s_cbranch_scc0 Lj6_141
    s_mov_b32 s68, s34
    s_branch Lc_138
Lj6_141:
    s_cmp_eq_u32 s35, 6
    s_cbranch_scc0 Lj7_142
    s_add_u32 s68, s34, 32
    s_cmp_lt_u32 s34, 16
    s_cbranch_scc1 Lc_138
    s_sub_u32 s68, s34, 16
    s_branch Ld_139
Lj7_142:
    s_sub_u32 s68, s34, 12
    s_cmp_ge_u32 s34, 28
    s_cbranch_scc1 Ld_139
    s_branch Lnc_140
Lc_138:
    s_mov_b32 s69, 1
    s_branch Lrd_143
Ld_139:
    s_mov_b32 s69, 2
    s_branch Lrd_143
Lnc_140:
    s_mul_i32 s71, s34, 3
    s_add_u32 s71, s71, s33
    s_cmp_lt_u32 s71, 80
    s_cbranch_scc0 Lrd_143
    s_cmp_lt_u32 s33, 3
    s_cbranch_scc0 Lrd_143
    s_mov_b32 s70, 1
Lrd_143:
    s_cmp_ge_u32 s35, 3
    s_cbranch_scc0 Lnb2_144
    s_cmp_lt_u32 s35, 5
    s_cbranch_scc0 Lnb2_144
    s_mov_b32 s36, s12
    s_and_b32 s37, s13, 0xffff
    s_mov_b32 s38, 7864320
    s_mov_b32 s39, 0x20000
    s_mul_i32 s62, s34, 192
    s_mul_i32 s63, s33, 48
    s_add_u32 s62, s62, s63
    v_lshrrev_b32 v6, 4, v1
    v_mul_u32_u24 v6, 3, v6
    v_add_u32 v6, s62, v6
    v_mul_u32_u24 v6, 1280, v6
    v_and_b32 v7, 15, v1
    v_lshl_add_u32 v6, v7, 4, v6
    s_lshl_b32 s62, s35, 8
    v_add_u32 v6, s62, v6
    s_mov_b32 s62, 0
    buffer_load_dwordx4 v[52:55], v6, s[36:39], s62 offen nt
    s_mov_b32 s62, 1280
    buffer_load_dwordx4 v[56:59], v6, s[36:39], s62 offen nt
    s_mov_b32 s62, 2560
    buffer_load_dwordx4 v[60:63], v6, s[36:39], s62 offen nt
    s_mov_b32 s62, 15360
    buffer_load_dwordx4 v[64:67], v6, s[36:39], s62 offen nt
    s_mov_b32 s62, 16640
    buffer_load_dwordx4 v[68:71], v6, s[36:39], s62 offen nt
    s_mov_b32 s62, 17920
    buffer_load_dwordx4 v[72:75], v6, s[36:39], s62 offen nt
    s_mov_b32 s62, 30720
    buffer_load_dwordx4 v[76:79], v6, s[36:39], s62 offen nt
    s_mov_b32 s62, 32000
    buffer_load_dwordx4 v[80:83], v6, s[36:39], s62 offen nt
    s_mov_b32 s62, 33280
    buffer_load_dwordx4 v[84:87], v6, s[36:39], s62 offen nt
    s_mov_b32 s62, 46080
    buffer_load_dwordx4 v[88:91], v6, s[36:39], s62 offen nt
    s_mov_b32 s62, 47360
    buffer_load_dwordx4 v[92:95], v6, s[36:39], s62 offen nt
    s_mov_b32 s62, 48640
    buffer_load_dwordx4 v[96:99], v6, s[36:39], s62 offen nt
    s_waitcnt vmcnt(0)
    v_perm_b32 v132, v56, v52, s97
    v_perm_b32 v133, v64, v60, s97
    v_perm_b32 v134, v72, v68, s97
    v_perm_b32 v135, v80, v76, s97
    v_perm_b32 v136, v88, v84, s97
    v_perm_b32 v137, v96, v92, s97
    v_perm_b32 v140, v56, v52, s98
    v_perm_b32 v141, v64, v60, s98
    v_perm_b32 v142, v72, v68, s98
    v_perm_b32 v143, v80, v76, s98
    v_perm_b32 v144, v88, v84, s98
    v_perm_b32 v145, v96, v92, s98
    v_perm_b32 v148, v57, v53, s97
    v_perm_b32 v149, v65, v61, s97
    v_perm_b32 v150, v73, v69, s97
    v_perm_b32 v151, v81, v77, s97
    v_perm_b32 v152, v89, v85, s97
    v_perm_b32 v153, v97, v93, s97
    v_perm_b32 v156, v57, v53, s98
    v_perm_b32 v157, v65, v61, s98
    v_perm_b32 v158, v73, v69, s98
    v_perm_b32 v159, v81, v77, s98
    v_perm_b32 v160, v89, v85, s98
    v_perm_b32 v161, v97, v93, s98
    v_perm_b32 v164, v58, v54, s97
    v_perm_b32 v165, v66, v62, s97
    v_perm_b32 v166, v74, v70, s97
    v_perm_b32 v167, v82, v78, s97
    v_perm_b32 v168, v90, v86, s97
    v_perm_b32 v169, v98, v94, s97
    v_perm_b32 v172, v58, v54, s98
    v_perm_b32 v173, v66, v62, s98
    v_perm_b32 v174, v74, v70, s98
    v_perm_b32 v175, v82, v78, s98
    v_perm_b32 v176, v90, v86, s98
    v_perm_b32 v177, v98, v94, s98
    v_perm_b32 v180, v59, v55, s97
    v_perm_b32 v181, v67, v63, s97
    v_perm_b32 v182, v75, v71, s97
    v_perm_b32 v183, v83, v79, s97
    v_perm_b32 v184, v91, v87, s97
    v_perm_b32 v185, v99, v95, s97
    v_perm_b32 v188, v59, v55, s98
    v_perm_b32 v189, v67, v63, s98
    v_perm_b32 v190, v75, v71, s98
    v_perm_b32 v191, v83, v79, s98
    v_perm_b32 v192, v91, v87, s98
    v_perm_b32 v193, v99, v95, s98
Lnb2_144:
    s_cmp_eq_u32 s69, 1
    s_cbranch_scc0 Lhc_145
    s_mov_b32 s36, s16
    s_and_b32 s37, s17, 0xffff
    s_mov_b32 s38, 1966080
    s_mov_b32 s39, 0x20000
    s_mul_i32 s62, s33, 160
    v_lshrrev_b32 v6, 4, v1
    v_lshlrev_b32 v6, 3, v6
    v_add_u32 v6, s62, v6
    v_mul_u32_u24 v6, 3072, v6
    v_and_b32 v7, 15, v1
    v_lshl_add_u32 v6, v7, 2, v6
    s_lshl_b32 s62, s68, 6
    v_add_u32 v6, s62, v6
    s_mov_b32 s62, 0
    buffer_load_dword v44, v6, s[36:39], s62 offen nt
    s_mov_b32 s62, 3072
    buffer_load_dword v45, v6, s[36:39], s62 offen nt
    s_mov_b32 s62, 6144
    buffer_load_dword v46, v6, s[36:39], s62 offen nt
    s_mov_b32 s62, 9216
    buffer_load_dword v47, v6, s[36:39], s62 offen nt
    s_mov_b32 s62, 12288
    buffer_load_dword v48, v6, s[36:39], s62 offen nt
    s_mov_b32 s62, 15360
    buffer_load_dword v49, v6, s[36:39], s62 offen nt
    s_mov_b32 s62, 18432
    buffer_load_dword v50, v6, s[36:39], s62 offen nt
    s_mov_b32 s62, 21504
    buffer_load_dword v51, v6, s[36:39], s62 offen nt
    s_mov_b32 s62, 98304
    buffer_load_dword v52, v6, s[36:39], s62 offen nt
    s_mov_b32 s62, 101376
    buffer_load_dword v53, v6, s[36:39], s62 offen nt
    s_mov_b32 s62, 104448
    buffer_load_dword v54, v6, s[36:39], s62 offen nt
    s_mov_b32 s62, 107520
    buffer_load_dword v55, v6, s[36:39], s62 offen nt
    s_mov_b32 s62, 110592
    buffer_load_dword v56, v6, s[36:39], s62 offen nt
    s_mov_b32 s62, 113664
    buffer_load_dword v57, v6, s[36:39], s62 offen nt
    s_mov_b32 s62, 116736
    buffer_load_dword v58, v6, s[36:39], s62 offen nt
    s_mov_b32 s62, 119808
    buffer_load_dword v59, v6, s[36:39], s62 offen nt
    s_mov_b32 s62, 196608
    buffer_load_dword v60, v6, s[36:39], s62 offen nt
    s_mov_b32 s62, 199680
    buffer_load_dword v61, v6, s[36:39], s62 offen nt
    s_mov_b32 s62, 202752
    buffer_load_dword v62, v6, s[36:39], s62 offen nt
    s_mov_b32 s62, 205824
    buffer_load_dword v63, v6, s[36:39], s62 offen nt
    s_mov_b32 s62, 208896
    buffer_load_dword v64, v6, s[36:39], s62 offen nt
    s_mov_b32 s62, 211968
    buffer_load_dword v65, v6, s[36:39], s62 offen nt
    s_mov_b32 s62, 215040
    buffer_load_dword v66, v6, s[36:39], s62 offen nt
    s_mov_b32 s62, 218112
    buffer_load_dword v67, v6, s[36:39], s62 offen nt
    s_mov_b32 s62, 294912
    buffer_load_dword v68, v6, s[36:39], s62 offen nt
    s_mov_b32 s62, 297984
    buffer_load_dword v69, v6, s[36:39], s62 offen nt
    s_mov_b32 s62, 301056
    buffer_load_dword v70, v6, s[36:39], s62 offen nt
    s_mov_b32 s62, 304128
    buffer_load_dword v71, v6, s[36:39], s62 offen nt
    s_mov_b32 s62, 307200
    buffer_load_dword v72, v6, s[36:39], s62 offen nt
    s_mov_b32 s62, 310272
    buffer_load_dword v73, v6, s[36:39], s62 offen nt
    s_mov_b32 s62, 313344
    buffer_load_dword v74, v6, s[36:39], s62 offen nt
    s_mov_b32 s62, 316416
    buffer_load_dword v75, v6, s[36:39], s62 offen nt
    s_mov_b32 s62, 393216
    buffer_load_dword v76, v6, s[36:39], s62 offen nt
    s_mov_b32 s62, 396288
    buffer_load_dword v77, v6, s[36:39], s62 offen nt
    s_mov_b32 s62, 399360
    buffer_load_dword v78, v6, s[36:39], s62 offen nt
    s_mov_b32 s62, 402432
    buffer_load_dword v79, v6, s[36:39], s62 offen nt
    s_mov_b32 s62, 405504
    buffer_load_dword v80, v6, s[36:39], s62 offen nt
    s_mov_b32 s62, 408576
    buffer_load_dword v81, v6, s[36:39], s62 offen nt
    s_mov_b32 s62, 411648
    buffer_load_dword v82, v6, s[36:39], s62 offen nt
    s_mov_b32 s62, 414720
    buffer_load_dword v83, v6, s[36:39], s62 offen nt
    s_waitcnt vmcnt(0)
    v_perm_b32 v36, v45, v44, s97
    v_perm_b32 v37, v47, v46, s97
    v_perm_b32 v38, v49, v48, s97
    v_perm_b32 v39, v51, v50, s97
    v_perm_b32 v40, v45, v44, s98
    v_perm_b32 v41, v47, v46, s98
    v_perm_b32 v42, v49, v48, s98
    v_perm_b32 v43, v51, v50, s98
    v_perm_b32 v44, v53, v52, s97
    v_perm_b32 v45, v55, v54, s97
    v_perm_b32 v46, v57, v56, s97
    v_perm_b32 v47, v59, v58, s97
    v_perm_b32 v48, v53, v52, s98
    v_perm_b32 v49, v55, v54, s98
    v_perm_b32 v50, v57, v56, s98
    v_perm_b32 v51, v59, v58, s98
    v_perm_b32 v52, v61, v60, s97
    v_perm_b32 v53, v63, v62, s97
    v_perm_b32 v54, v65, v64, s97
    v_perm_b32 v55, v67, v66, s97
    v_perm_b32 v56, v61, v60, s98
    v_perm_b32 v57, v63, v62, s98
    v_perm_b32 v58, v65, v64, s98
    v_perm_b32 v59, v67, v66, s98
    v_perm_b32 v60, v69, v68, s97
    v_perm_b32 v61, v71, v70, s97
    v_perm_b32 v62, v73, v72, s97
    v_perm_b32 v63, v75, v74, s97
    v_perm_b32 v64, v69, v68, s98
    v_perm_b32 v65, v71, v70, s98
    v_perm_b32 v66, v73, v72, s98
    v_perm_b32 v67, v75, v74, s98
    v_perm_b32 v68, v77, v76, s97
    v_perm_b32 v69, v79, v78, s97
    v_perm_b32 v70, v81, v80, s97
    v_perm_b32 v71, v83, v82, s97
    v_perm_b32 v72, v77, v76, s98
    v_perm_b32 v73, v79, v78, s98
    v_perm_b32 v74, v81, v80, s98
    v_perm_b32 v75, v83, v82, s98
Lhc_145:
    s_cmp_eq_u32 s69, 2
    s_cbranch_scc0 Lhd_146
    s_mov_b32 s36, s20
    s_and_b32 s37, s21, 0xffff
    s_mov_b32 s38, 1966080
    s_mov_b32 s39, 0x20000
    s_mul_i32 s62, s33, 384
    v_lshrrev_b32 v6, 4, v1
    v_lshlrev_b32 v6, 3, v6
    v_add_u32 v6, s62, v6
    v_mul_u32_u24 v6, 1280, v6
    v_and_b32 v7, 15, v1
    v_lshl_add_u32 v6, v7, 2, v6
    s_lshl_b32 s62, s68, 6
    v_add_u32 v6, s62, v6
    s_mov_b32 s62, 0
    buffer_load_dword v108, v6, s[36:39], s62 offen nt
    s_mov_b32 s62, 1280
    buffer_load_dword v109, v6, s[36:39], s62 offen nt
    s_mov_b32 s62, 2560
    buffer_load_dword v110, v6, s[36:39], s62 offen nt
    s_mov_b32 s62, 3840
    buffer_load_dword v111, v6, s[36:39], s62 offen nt
    s_mov_b32 s62, 5120
    buffer_load_dword v112, v6, s[36:39], s62 offen nt
    s_mov_b32 s62, 6400
    buffer_load_dword v113, v6, s[36:39], s62 offen nt
    s_mov_b32 s62, 7680
    buffer_load_dword v114, v6, s[36:39], s62 offen nt
    s_mov_b32 s62, 8960
    buffer_load_dword v115, v6, s[36:39], s62 offen nt
    s_mov_b32 s62, 40960
    buffer_load_dword v116, v6, s[36:39], s62 offen nt
    s_mov_b32 s62, 42240
    buffer_load_dword v117, v6, s[36:39], s62 offen nt
    s_mov_b32 s62, 43520
    buffer_load_dword v118, v6, s[36:39], s62 offen nt
    s_mov_b32 s62, 44800
    buffer_load_dword v119, v6, s[36:39], s62 offen nt
    s_mov_b32 s62, 46080
    buffer_load_dword v120, v6, s[36:39], s62 offen nt
    s_mov_b32 s62, 47360
    buffer_load_dword v121, v6, s[36:39], s62 offen nt
    s_mov_b32 s62, 48640
    buffer_load_dword v122, v6, s[36:39], s62 offen nt
    s_mov_b32 s62, 49920
    buffer_load_dword v123, v6, s[36:39], s62 offen nt
    s_mov_b32 s62, 81920
    buffer_load_dword v124, v6, s[36:39], s62 offen nt
    s_mov_b32 s62, 83200
    buffer_load_dword v125, v6, s[36:39], s62 offen nt
    s_mov_b32 s62, 84480
    buffer_load_dword v126, v6, s[36:39], s62 offen nt
    s_mov_b32 s62, 85760
    buffer_load_dword v127, v6, s[36:39], s62 offen nt
    s_mov_b32 s62, 87040
    buffer_load_dword v128, v6, s[36:39], s62 offen nt
    s_mov_b32 s62, 88320
    buffer_load_dword v129, v6, s[36:39], s62 offen nt
    s_mov_b32 s62, 89600
    buffer_load_dword v130, v6, s[36:39], s62 offen nt
    s_mov_b32 s62, 90880
    buffer_load_dword v131, v6, s[36:39], s62 offen nt
    s_mov_b32 s62, 122880
    buffer_load_dword v132, v6, s[36:39], s62 offen nt
    s_mov_b32 s62, 124160
    buffer_load_dword v133, v6, s[36:39], s62 offen nt
    s_mov_b32 s62, 125440
    buffer_load_dword v134, v6, s[36:39], s62 offen nt
    s_mov_b32 s62, 126720
    buffer_load_dword v135, v6, s[36:39], s62 offen nt
    s_mov_b32 s62, 128000
    buffer_load_dword v136, v6, s[36:39], s62 offen nt
    s_mov_b32 s62, 129280
    buffer_load_dword v137, v6, s[36:39], s62 offen nt
    s_mov_b32 s62, 130560
    buffer_load_dword v138, v6, s[36:39], s62 offen nt
    s_mov_b32 s62, 131840
    buffer_load_dword v139, v6, s[36:39], s62 offen nt
    s_mov_b32 s62, 163840
    buffer_load_dword v140, v6, s[36:39], s62 offen nt
    s_mov_b32 s62, 165120
    buffer_load_dword v141, v6, s[36:39], s62 offen nt
    s_mov_b32 s62, 166400
    buffer_load_dword v142, v6, s[36:39], s62 offen nt
    s_mov_b32 s62, 167680
    buffer_load_dword v143, v6, s[36:39], s62 offen nt
    s_mov_b32 s62, 168960
    buffer_load_dword v144, v6, s[36:39], s62 offen nt
    s_mov_b32 s62, 170240
    buffer_load_dword v145, v6, s[36:39], s62 offen nt
    s_mov_b32 s62, 171520
    buffer_load_dword v146, v6, s[36:39], s62 offen nt
    s_mov_b32 s62, 172800
    buffer_load_dword v147, v6, s[36:39], s62 offen nt
    s_mov_b32 s62, 204800
    buffer_load_dword v148, v6, s[36:39], s62 offen nt
    s_mov_b32 s62, 206080
    buffer_load_dword v149, v6, s[36:39], s62 offen nt
    s_mov_b32 s62, 207360
    buffer_load_dword v150, v6, s[36:39], s62 offen nt
    s_mov_b32 s62, 208640
    buffer_load_dword v151, v6, s[36:39], s62 offen nt
    s_mov_b32 s62, 209920
    buffer_load_dword v152, v6, s[36:39], s62 offen nt
    s_mov_b32 s62, 211200
    buffer_load_dword v153, v6, s[36:39], s62 offen nt
    s_mov_b32 s62, 212480
    buffer_load_dword v154, v6, s[36:39], s62 offen nt
    s_mov_b32 s62, 213760
    buffer_load_dword v155, v6, s[36:39], s62 offen nt
    s_waitcnt vmcnt(0)
    v_perm_b32 v100, v109, v108, s97
    v_perm_b32 v101, v111, v110, s97
    v_perm_b32 v102, v113, v112, s97
    v_perm_b32 v103, v115, v114, s97
    v_perm_b32 v104, v109, v108, s98
    v_perm_b32 v105, v111, v110, s98
    v_perm_b32 v106, v113, v112, s98
    v_perm_b32 v107, v115, v114, s98
    v_perm_b32 v108, v117, v116, s97
    v_perm_b32 v109, v119, v118, s97
    v_perm_b32 v110, v121, v120, s97
    v_perm_b32 v111, v123, v122, s97
    v_perm_b32 v112, v117, v116, s98
    v_perm_b32 v113, v119, v118, s98
    v_perm_b32 v114, v121, v120, s98
    v_perm_b32 v115, v123, v122, s98
    v_perm_b32 v116, v125, v124, s97
    v_perm_b32 v117, v127, v126, s97
    v_perm_b32 v118, v129, v128, s97
    v_perm_b32 v119, v131, v130, s97
    v_perm_b32 v120, v125, v124, s98
    v_perm_b32 v121, v127, v126, s98
    v_perm_b32 v122, v129, v128, s98
    v_perm_b32 v123, v131, v130, s98
    v_perm_b32 v124, v133, v132, s97
    v_perm_b32 v125, v135, v134, s97
    v_perm_b32 v126, v137, v136, s97
    v_perm_b32 v127, v139, v138, s97
    v_perm_b32 v128, v133, v132, s98
    v_perm_b32 v129, v135, v134, s98
    v_perm_b32 v130, v137, v136, s98
    v_perm_b32 v131, v139, v138, s98
    v_perm_b32 v132, v141, v140, s97
    v_perm_b32 v133, v143, v142, s97
    v_perm_b32 v134, v145, v144, s97
    v_perm_b32 v135, v147, v146, s97
    v_perm_b32 v136, v141, v140, s98
    v_perm_b32 v137, v143, v142, s98
    v_perm_b32 v138, v145, v144, s98
    v_perm_b32 v139, v147, v146, s98
    v_perm_b32 v140, v149, v148, s97
    v_perm_b32 v141, v151, v150, s97
    v_perm_b32 v142, v153, v152, s97
    v_perm_b32 v143, v155, v154, s97
    v_perm_b32 v144, v149, v148, s98
    v_perm_b32 v145, v151, v150, s98
    v_perm_b32 v146, v153, v152, s98
    v_perm_b32 v147, v155, v154, s98
Lhd_146:
    s_mul_i32 s62, s33, 24576
    s_mul_i32 s63, s34, 768
    s_add_u32 s62, s62, s63
    s_add_u32 s62, s62, 65536
    v_lshlrev_b32 v6, 4, v1
    s_mov_b32 exec_lo, -1
    s_mov_b32 exec_hi, 0xffff
    s_branch Lpoll_147
Lpollr_148:
    s_sleep 2
    s_sub_u32 s96, s96, 1
    s_cbranch_scc1 Labort
Lpoll_147:
    buffer_load_dwordx4 v[32:35], v6, s[40:43], s62 offen sc1
    s_waitcnt vmcnt(0)
    v_xor_b32 v28, s32, v33
    v_xor_b32 v29, s32, v35
    v_or_b32 v28, v28, v29
    v_cmp_ne_u32 vcc, 0, v28
    s_nop 1
    s_cbranch_vccnz Lpollr_148
Lpolld_149:
    v_mov_b32 v33, v34
    s_mul_i32 s62, s33, 384
    s_add_u32 s62, s62, 160768
    v_lshlrev_b32 v6, 3, v1
    v_add_u32 v6, s62, v6
    ds_write_b64 v6, v[32:33]
    s_mov_b64 exec, 1
    ds_add_u32 v9, v3 offset:16
    s_mov_b64 exec, -1
    s_cmp_lt_u32 s35, 3
    s_cbranch_scc0 Lbd_150
    s_mov_b32 s36, s12
    s_and_b32 s37, s13, 0xffff
    s_mov_b32 s38, 7864320
    s_mov_b32 s39, 0x20000
    s_mul_i32 s62, s34, 192
    s_mul_i32 s63, s33, 48
    s_add_u32 s62, s62, s63
    v_lshrrev_b32 v6, 4, v1
    v_mul_u32_u24 v6, 3, v6
    v_add_u32 v6, s62, v6
    v_mul_u32_u24 v6, 1280, v6
    v_and_b32 v7, 15, v1
    v_lshl_add_u32 v6, v7, 4, v6
    s_lshl_b32 s62, s35, 8
    v_add_u32 v6, s62, v6
    s_mov_b32 s62, 0
    buffer_load_dwordx4 v[52:55], v6, s[36:39], s62 offen nt
    s_mov_b32 s62, 1280
    buffer_load_dwordx4 v[56:59], v6, s[36:39], s62 offen nt
    s_mov_b32 s62, 2560
    buffer_load_dwordx4 v[60:63], v6, s[36:39], s62 offen nt
    s_mov_b32 s62, 15360
    buffer_load_dwordx4 v[64:67], v6, s[36:39], s62 offen nt
    s_mov_b32 s62, 16640
    buffer_load_dwordx4 v[68:71], v6, s[36:39], s62 offen nt
    s_mov_b32 s62, 17920
    buffer_load_dwordx4 v[72:75], v6, s[36:39], s62 offen nt
    s_mov_b32 s62, 30720
    buffer_load_dwordx4 v[76:79], v6, s[36:39], s62 offen nt
    s_mov_b32 s62, 32000
    buffer_load_dwordx4 v[80:83], v6, s[36:39], s62 offen nt
    s_mov_b32 s62, 33280
    buffer_load_dwordx4 v[84:87], v6, s[36:39], s62 offen nt
    s_mov_b32 s62, 46080
    buffer_load_dwordx4 v[88:91], v6, s[36:39], s62 offen nt
    s_mov_b32 s62, 47360
    buffer_load_dwordx4 v[92:95], v6, s[36:39], s62 offen nt
    s_mov_b32 s62, 48640
    buffer_load_dwordx4 v[96:99], v6, s[36:39], s62 offen nt
    s_waitcnt vmcnt(0)
    v_perm_b32 v132, v56, v52, s97
    v_perm_b32 v133, v64, v60, s97
    v_perm_b32 v134, v72, v68, s97
    v_perm_b32 v135, v80, v76, s97
    v_perm_b32 v136, v88, v84, s97
    v_perm_b32 v137, v96, v92, s97
    v_perm_b32 v140, v56, v52, s98
    v_perm_b32 v141, v64, v60, s98
    v_perm_b32 v142, v72, v68, s98
    v_perm_b32 v143, v80, v76, s98
    v_perm_b32 v144, v88, v84, s98
    v_perm_b32 v145, v96, v92, s98
    v_perm_b32 v148, v57, v53, s97
    v_perm_b32 v149, v65, v61, s97
    v_perm_b32 v150, v73, v69, s97
    v_perm_b32 v151, v81, v77, s97
    v_perm_b32 v152, v89, v85, s97
    v_perm_b32 v153, v97, v93, s97
    v_perm_b32 v156, v57, v53, s98
    v_perm_b32 v157, v65, v61, s98
    v_perm_b32 v158, v73, v69, s98
    v_perm_b32 v159, v81, v77, s98
    v_perm_b32 v160, v89, v85, s98
    v_perm_b32 v161, v97, v93, s98
    v_perm_b32 v164, v58, v54, s97
    v_perm_b32 v165, v66, v62, s97
    v_perm_b32 v166, v74, v70, s97
    v_perm_b32 v167, v82, v78, s97
    v_perm_b32 v168, v90, v86, s97
    v_perm_b32 v169, v98, v94, s97
    v_perm_b32 v172, v58, v54, s98
    v_perm_b32 v173, v66, v62, s98
    v_perm_b32 v174, v74, v70, s98
    v_perm_b32 v175, v82, v78, s98
    v_perm_b32 v176, v90, v86, s98
    v_perm_b32 v177, v98, v94, s98
    v_perm_b32 v180, v59, v55, s97
    v_perm_b32 v181, v67, v63, s97
    v_perm_b32 v182, v75, v71, s97
    v_perm_b32 v183, v83, v79, s97
    v_perm_b32 v184, v91, v87, s97
    v_perm_b32 v185, v99, v95, s97
    v_perm_b32 v188, v59, v55, s98
    v_perm_b32 v189, v67, v63, s98
    v_perm_b32 v190, v75, v71, s98
    v_perm_b32 v191, v83, v79, s98
    v_perm_b32 v192, v91, v87, s98
    v_perm_b32 v193, v99, v95, s98
Lbd_150:
    s_cmp_eq_u32 s69, 1
    s_cbranch_scc0 Lpc_152
    s_mul_i32 s62, s33, 15360
    s_add_u32 s62, s62, 11776
    s_add_u32 s63, s62, 2560
    v_lshlrev_b32 v6, 3, v1
    s_branch Lpoll_154
Lpollr_155:
    s_sleep 8
    s_sub_u32 s96, s96, 1
    s_cbranch_scc1 Labort
Lpoll_154:
    buffer_load_dwordx2 v[160:161], v6, s[40:43], s62 offen offset:0 sc1
    buffer_load_dwordx2 v[162:163], v6, s[40:43], s62 offen offset:512 sc1
    buffer_load_dwordx2 v[164:165], v6, s[40:43], s62 offen offset:1024 sc1
    buffer_load_dwordx2 v[166:167], v6, s[40:43], s62 offen offset:1536 sc1
    buffer_load_dwordx2 v[168:169], v6, s[40:43], s62 offen offset:2048 sc1
    buffer_load_dwordx2 v[170:171], v6, s[40:43], s63 offen offset:0 sc1
    buffer_load_dwordx2 v[172:173], v6, s[40:43], s63 offen offset:512 sc1
    buffer_load_dwordx2 v[174:175], v6, s[40:43], s63 offen offset:1024 sc1
    buffer_load_dwordx2 v[176:177], v6, s[40:43], s63 offen offset:1536 sc1
    buffer_load_dwordx2 v[178:179], v6, s[40:43], s63 offen offset:2048 sc1
    s_waitcnt vmcnt(0)
    v_xor_b32 v28, s32, v161
    v_xor_b32 v29, s32, v163
    v_xor_b32 v30, s32, v165
    v_or3_b32 v28, v28, v29, v30
    v_xor_b32 v29, s32, v167
    v_xor_b32 v30, s32, v169
    v_or3_b32 v28, v28, v29, v30
    v_xor_b32 v29, s32, v171
    v_xor_b32 v30, s32, v173
    v_or3_b32 v28, v28, v29, v30
    v_xor_b32 v29, s32, v175
    v_xor_b32 v30, s32, v177
    v_or3_b32 v28, v28, v29, v30
    v_xor_b32 v29, s32, v179
    v_or_b32 v28, v28, v29
    v_cmp_ne_u32 vcc, 0, v28
    s_nop 1
    s_cbranch_vccnz Lpollr_155
Lpolld_156:
    v_lshlrev_b32 v150, 16, v160
    v_and_b32 v151, 0xffff0000, v160
    v_lshlrev_b32 v152, 16, v162
    v_and_b32 v153, 0xffff0000, v162
    v_lshlrev_b32 v154, 16, v164
    v_and_b32 v155, 0xffff0000, v164
    v_lshlrev_b32 v156, 16, v166
    v_and_b32 v157, 0xffff0000, v166
    v_lshlrev_b32 v158, 16, v168
    v_and_b32 v159, 0xffff0000, v168
    v_lshlrev_b32 v140, 16, v170
    v_and_b32 v141, 0xffff0000, v170
    v_add_f32 v140, 1.0, v140
    v_add_f32 v141, 1.0, v141
    v_cvt_pk_bf16_f32 v28, v140, v141
    v_lshlrev_b32 v140, 16, v28
    v_and_b32 v141, 0xffff0000, v28
    v_lshlrev_b32 v142, 16, v172
    v_and_b32 v143, 0xffff0000, v172
    v_add_f32 v142, 1.0, v142
    v_add_f32 v143, 1.0, v143
    v_cvt_pk_bf16_f32 v28, v142, v143
    v_lshlrev_b32 v142, 16, v28
    v_and_b32 v143, 0xffff0000, v28
    v_lshlrev_b32 v144, 16, v174
    v_and_b32 v145, 0xffff0000, v174
    v_add_f32 v144, 1.0, v144
    v_add_f32 v145, 1.0, v145
    v_cvt_pk_bf16_f32 v28, v144, v145
    v_lshlrev_b32 v144, 16, v28
    v_and_b32 v145, 0xffff0000, v28
    v_lshlrev_b32 v146, 16, v176
    v_and_b32 v147, 0xffff0000, v176
    v_add_f32 v146, 1.0, v146
    v_add_f32 v147, 1.0, v147
    v_cvt_pk_bf16_f32 v28, v146, v147
    v_lshlrev_b32 v146, 16, v28
    v_and_b32 v147, 0xffff0000, v28
    v_lshlrev_b32 v148, 16, v178
    v_and_b32 v149, 0xffff0000, v178
    v_add_f32 v148, 1.0, v148
    v_add_f32 v149, 1.0, v149
    v_cvt_pk_bf16_f32 v28, v148, v149
    v_lshlrev_b32 v148, 16, v28
    v_and_b32 v149, 0xffff0000, v28
    s_branch Lmid_151
Lpc_152:
    s_cmp_eq_u32 s69, 2
    s_cbranch_scc0 Lpd_153
    v_lshrrev_b32 v6, 4, v1
    v_mul_u32_u24 v6, 15360, v6
    v_and_b32 v7, 15, v1
    v_lshl_add_u32 v6, v7, 3, v6
    s_lshl_b32 s62, s68, 7
    s_add_u32 s62, s62, 16896
    s_branch Lpoll_157
Lpollr_158:
    s_sleep 8
    s_sub_u32 s96, s96, 1
    s_cbranch_scc1 Labort
Lpoll_157:
    buffer_load_dwordx2 v[240:241], v6, s[40:43], s62 offen sc1
    s_waitcnt vmcnt(0)
    v_xor_b32 v28, s32, v241
    v_cmp_ne_u32 vcc, 0, v28
    s_nop 1
    s_cbranch_vccnz Lpollr_158
Lpolld_159:
    s_branch Lmid_151
Lpd_153:
    s_cmp_eq_u32 s70, 1
    s_cbranch_scc0 Lmid_151
    s_mov_b32 s44, s4
    s_and_b32 s45, s5, 0xffff
    s_mov_b32 s46, 5120
    s_mov_b32 s47, 0x20000
    v_and_b32 v7, 15, v1
    s_and_b32 s63, s71, 3
    s_lshr_b32 s64, s71, 2
    s_mul_i32 s62, s63, 1280
    s_lshl_b32 s65, s64, 6
    s_add_u32 s62, s62, s65
    v_lshlrev_b32 v8, 2, v7
    buffer_load_dword v180, v8, s[44:47], s62 offen
    v_lshlrev_b32 v8, 3, v7
    s_mul_i32 s62, s63, 15360
    s_lshl_b32 s65, s64, 7
    s_add_u32 s62, s62, s65
    s_add_u32 s62, s62, 9216
    s_branch Lpoll_160
Lpollr_161:
    s_sleep 8
    s_sub_u32 s96, s96, 1
    s_cbranch_scc1 Labort
Lpoll_160:
    buffer_load_dwordx2 v[182:183], v8, s[40:43], s62 offen sc1
    s_waitcnt vmcnt(0)
    v_xor_b32 v28, s32, v183
    v_cmp_ne_u32 vcc, 0, v28
    s_nop 1
    s_cbranch_vccnz Lpollr_161
Lpolld_162:
Lmid_151:
    s_lshl_b32 s61, s35, 2
    s_add_u32 s61, s61, s33
    s_lshl_b32 s95, s33, 10
    s_add_u32 s95, s95, 147456
    s_mov_b32 s60, 0
Lw_163:
    ds_read_b32 v8, v2 offset:32
    s_waitcnt lgkmcnt(0)
    v_readfirstlane_b32 s90, v8
    s_nop 0
    s_cmp_gt_u32 s90, s60
    s_cbranch_scc1 Lwd_164
    s_sleep 4
    s_sub_u32 s96, s96, 1
    s_cbranch_scc1 Labort
    s_branch Lw_163
Lwd_164:
    s_lshl_b32 s62, s33, 5
    s_add_u32 s62, s62, 162304
    v_mov_b32 v6, s62
    ds_read_b64 v[12:13], v6
    s_lshl_b32 s63, s34, 2
    s_add_u32 s63, s63, 0
    s_lshl_b32 s63, s63, 9
    s_add_u32 s63, s63, 917504
    s_lshl_b32 s62, s61, 4
    s_add_u32 s62, s62, s63
    s_waitcnt lgkmcnt(0)
    v_mov_b32 v14, v13
    v_mov_b32 v13, s32
    v_mov_b32 v15, s32
    v_mov_b32 v6, 0
    s_mov_b64 exec, 1
    buffer_store_dwordx4 v[12:15], v6, s[40:43], s62 offen sc1
    s_mov_b64 exec, -1
    s_mov_b32 s60, 1
Lw_165:
    ds_read_b32 v8, v2 offset:32
    s_waitcnt lgkmcnt(0)
    v_readfirstlane_b32 s90, v8
    s_nop 0
    s_cmp_gt_u32 s90, s60
    s_cbranch_scc1 Lwd_166
    s_sleep 4
    s_sub_u32 s96, s96, 1
    s_cbranch_scc1 Labort
    s_branch Lw_165
Lwd_166:
    s_lshl_b32 s62, s33, 5
    s_add_u32 s62, s62, 162312
    v_mov_b32 v6, s62
    ds_read_b64 v[12:13], v6
    s_lshl_b32 s63, s34, 2
    s_add_u32 s63, s63, 1
    s_lshl_b32 s63, s63, 9
    s_add_u32 s63, s63, 917504
    s_lshl_b32 s62, s61, 4
    s_add_u32 s62, s62, s63
    s_waitcnt lgkmcnt(0)
    v_mov_b32 v14, v13
    v_mov_b32 v13, s32
    v_mov_b32 v15, s32
    v_mov_b32 v6, 0
    s_mov_b64 exec, 1
    buffer_store_dwordx4 v[12:15], v6, s[40:43], s62 offen sc1
    s_mov_b64 exec, -1
    s_lshl_b32 s63, s34, 2
    s_add_u32 s63, s63, 0
    s_lshl_b32 s63, s63, 9
    s_add_u32 s63, s63, 917504
    v_lshlrev_b32 v6, 4, v1
    s_mov_b32 exec_lo, -1
    s_mov_b32 exec_hi, 0
    s_branch Lpoll_167
Lpollr_168:
    s_sleep 8
    s_sub_u32 s96, s96, 1
    s_cbranch_scc1 Labort
Lpoll_167:
    buffer_load_dwordx4 v[12:15], v6, s[40:43], s63 offen sc1
    s_waitcnt vmcnt(0)
    v_xor_b32 v28, s32, v13
    v_xor_b32 v29, s32, v15
    v_or_b32 v28, v28, v29
    v_cmp_ne_u32 vcc, 0, v28
    s_nop 1
    s_cbranch_vccnz Lpollr_168
Lpolld_169:
    s_mov_b64 exec, -1
    v_cmp_gt_u32 vcc, 32, v1
    v_mov_b32 v6, 0xff800000
    v_mov_b32 v7, 0
    s_nop 0
    v_cndmask_b32 v12, v6, v12, vcc
    v_cndmask_b32 v14, v7, v14, vcc
    v_mov_b32 v6, v12
    s_nop 1
    v_max_f32_dpp v6, v6, v6 row_ror:8 row_mask:0xf bank_mask:0xf
    s_nop 1
    v_max_f32_dpp v6, v6, v6 row_ror:4 row_mask:0xf bank_mask:0xf
    s_nop 1
    v_max_f32_dpp v6, v6, v6 row_ror:2 row_mask:0xf bank_mask:0xf
    s_nop 1
    v_max_f32_dpp v6, v6, v6 row_ror:1 row_mask:0xf bank_mask:0xf
    v_mov_b32 v8, v6
    s_nop 1
    v_permlane16_swap_b32 v8, v6
    v_max_f32 v6, v8, v6
    v_mov_b32 v8, v6
    s_nop 1
    v_permlane32_swap_b32 v8, v6
    v_max_f32 v6, v8, v6
    v_sub_f32 v7, v12, v6
    v_mul_f32 v7, 0x3fb8aa3b, v7
    v_exp_f32 v7, v7
    s_nop 0
    v_mul_f32 v7, v7, v14
    s_nop 1
    v_add_f32_dpp v7, v7, v7 row_ror:8 row_mask:0xf bank_mask:0xf
    s_nop 1
    v_add_f32_dpp v7, v7, v7 row_ror:4 row_mask:0xf bank_mask:0xf
    s_nop 1
    v_add_f32_dpp v7, v7, v7 row_ror:2 row_mask:0xf bank_mask:0xf
    s_nop 1
    v_add_f32_dpp v7, v7, v7 row_ror:1 row_mask:0xf bank_mask:0xf
    v_mov_b32 v8, v7
    s_nop 1
    v_permlane16_swap_b32 v8, v7
    v_add_f32 v7, v8, v7
    v_mov_b32 v8, v7
    s_nop 1
    v_permlane32_swap_b32 v8, v7
    v_add_f32 v7, v8, v7
    v_rcp_f32 v7, v7
    s_nop 1
    v_readfirstlane_b32 s92, v6
    v_readfirstlane_b32 s93, v7
    s_add_u32 s62, s95, 0
    v_lshlrev_b32 v6, 2, v1
    v_add_u32 v6, s62, v6
    ds_read_b32 v12, v6
    s_waitcnt lgkmcnt(0)
    v_lshlrev_b32 v14, 16, v12
    v_and_b32 v15, 0xffff0000, v12
    v_subrev_f32 v14, s92, v14
    v_subrev_f32 v15, s92, v15
    v_mul_f32 v14, 0x3fb8aa3b, v14
    v_mul_f32 v15, 0x3fb8aa3b, v15
    v_exp_f32 v14, v14
    v_exp_f32 v15, v15
    s_nop 0
    v_mul_f32 v14, s93, v14
    v_mul_f32 v15, s93, v15
    v_cvt_pk_bf16_f32 v12, v14, v15
    v_mov_b32 v7, 1
    ds_write_b32 v6, v12
    s_mov_b64 exec, 1
    ds_write_b32 v2, v7 offset:48
    s_mov_b64 exec, -1
    s_mov_b32 s60, 2
Lw_170:
    ds_read_b32 v8, v2 offset:32
    s_waitcnt lgkmcnt(0)
    v_readfirstlane_b32 s90, v8
    s_nop 0
    s_cmp_gt_u32 s90, s60
    s_cbranch_scc1 Lwd_171
    s_sleep 4
    s_sub_u32 s96, s96, 1
    s_cbranch_scc1 Labort
    s_branch Lw_170
Lwd_171:
    s_lshl_b32 s62, s33, 5
    s_add_u32 s62, s62, 162320
    v_mov_b32 v6, s62
    ds_read_b64 v[12:13], v6
    s_lshl_b32 s63, s34, 2
    s_add_u32 s63, s63, 2
    s_lshl_b32 s63, s63, 9
    s_add_u32 s63, s63, 917504
    s_lshl_b32 s62, s61, 4
    s_add_u32 s62, s62, s63
    s_waitcnt lgkmcnt(0)
    v_mov_b32 v14, v13
    v_mov_b32 v13, s32
    v_mov_b32 v15, s32
    v_mov_b32 v6, 0
    s_mov_b64 exec, 1
    buffer_store_dwordx4 v[12:15], v6, s[40:43], s62 offen sc1
    s_mov_b64 exec, -1
    s_lshl_b32 s63, s34, 2
    s_add_u32 s63, s63, 1
    s_lshl_b32 s63, s63, 9
    s_add_u32 s63, s63, 917504
    v_lshlrev_b32 v6, 4, v1
    s_mov_b32 exec_lo, -1
    s_mov_b32 exec_hi, 0
    s_branch Lpoll_172
Lpollr_173:
    s_sleep 8
    s_sub_u32 s96, s96, 1
    s_cbranch_scc1 Labort
Lpoll_172:
    buffer_load_dwordx4 v[12:15], v6, s[40:43], s63 offen sc1
    s_waitcnt vmcnt(0)
    v_xor_b32 v28, s32, v13
    v_xor_b32 v29, s32, v15
    v_or_b32 v28, v28, v29
    v_cmp_ne_u32 vcc, 0, v28
    s_nop 1
    s_cbranch_vccnz Lpollr_173
Lpolld_174:
    s_mov_b64 exec, -1
    v_cmp_gt_u32 vcc, 32, v1
    v_mov_b32 v6, 0xff800000
    v_mov_b32 v7, 0
    s_nop 0
    v_cndmask_b32 v12, v6, v12, vcc
    v_cndmask_b32 v14, v7, v14, vcc
    v_mov_b32 v6, v12
    s_nop 1
    v_max_f32_dpp v6, v6, v6 row_ror:8 row_mask:0xf bank_mask:0xf
    s_nop 1
    v_max_f32_dpp v6, v6, v6 row_ror:4 row_mask:0xf bank_mask:0xf
    s_nop 1
    v_max_f32_dpp v6, v6, v6 row_ror:2 row_mask:0xf bank_mask:0xf
    s_nop 1
    v_max_f32_dpp v6, v6, v6 row_ror:1 row_mask:0xf bank_mask:0xf
    v_mov_b32 v8, v6
    s_nop 1
    v_permlane16_swap_b32 v8, v6
    v_max_f32 v6, v8, v6
    v_mov_b32 v8, v6
    s_nop 1
    v_permlane32_swap_b32 v8, v6
    v_max_f32 v6, v8, v6
    v_sub_f32 v7, v12, v6
    v_mul_f32 v7, 0x3fb8aa3b, v7
    v_exp_f32 v7, v7
    s_nop 0
    v_mul_f32 v7, v7, v14
    s_nop 1
    v_add_f32_dpp v7, v7, v7 row_ror:8 row_mask:0xf bank_mask:0xf
    s_nop 1
    v_add_f32_dpp v7, v7, v7 row_ror:4 row_mask:0xf bank_mask:0xf
    s_nop 1
    v_add_f32_dpp v7, v7, v7 row_ror:2 row_mask:0xf bank_mask:0xf
    s_nop 1
    v_add_f32_dpp v7, v7, v7 row_ror:1 row_mask:0xf bank_mask:0xf
    v_mov_b32 v8, v7
    s_nop 1
    v_permlane16_swap_b32 v8, v7
    v_add_f32 v7, v8, v7
    v_mov_b32 v8, v7
    s_nop 1
    v_permlane32_swap_b32 v8, v7
    v_add_f32 v7, v8, v7
    v_rcp_f32 v7, v7
    s_nop 1
    v_readfirstlane_b32 s92, v6
    v_readfirstlane_b32 s93, v7
    s_add_u32 s62, s95, 256
    v_lshlrev_b32 v6, 2, v1
    v_add_u32 v6, s62, v6
    ds_read_b32 v12, v6
    s_waitcnt lgkmcnt(0)
    v_lshlrev_b32 v14, 16, v12
    v_and_b32 v15, 0xffff0000, v12
    v_subrev_f32 v14, s92, v14
    v_subrev_f32 v15, s92, v15
    v_mul_f32 v14, 0x3fb8aa3b, v14
    v_mul_f32 v15, 0x3fb8aa3b, v15
    v_exp_f32 v14, v14
    v_exp_f32 v15, v15
    s_nop 0
    v_mul_f32 v14, s93, v14
    v_mul_f32 v15, s93, v15
    v_cvt_pk_bf16_f32 v12, v14, v15
    v_mov_b32 v7, 2
    ds_write_b32 v6, v12
    s_mov_b64 exec, 1
    ds_write_b32 v2, v7 offset:48
    s_mov_b64 exec, -1
    s_mov_b32 s60, 3
Lw_175:
    ds_read_b32 v8, v2 offset:32
    s_waitcnt lgkmcnt(0)
    v_readfirstlane_b32 s90, v8
    s_nop 0
    s_cmp_gt_u32 s90, s60
    s_cbranch_scc1 Lwd_176
    s_sleep 4
    s_sub_u32 s96, s96, 1
    s_cbranch_scc1 Labort
    s_branch Lw_175
Lwd_176:
    s_lshl_b32 s62, s33, 5
    s_add_u32 s62, s62, 162328
    v_mov_b32 v6, s62
    ds_read_b64 v[12:13], v6
    s_lshl_b32 s63, s34, 2
    s_add_u32 s63, s63, 3
    s_lshl_b32 s63, s63, 9
    s_add_u32 s63, s63, 917504
    s_lshl_b32 s62, s61, 4
    s_add_u32 s62, s62, s63
    s_waitcnt lgkmcnt(0)
    v_mov_b32 v14, v13
    v_mov_b32 v13, s32
    v_mov_b32 v15, s32
    v_mov_b32 v6, 0
    s_mov_b64 exec, 1
    buffer_store_dwordx4 v[12:15], v6, s[40:43], s62 offen sc1
    s_mov_b64 exec, -1
    s_add_u32 s62, s95, 832
    v_lshlrev_b32 v6, 2, v1
    v_add_u32 v6, s62, v6
    ds_read_b32 v16, v6
    v_mov_b32 v17, s32
    v_lshrrev_b32 v7, 4, v1
    v_lshlrev_b32 v7, 12, v7
    v_and_b32 v8, 15, v1
    v_lshl_add_u32 v7, v8, 3, v7
    s_lshl_b32 s62, s34, 7
    s_add_u32 s62, s62, 32
    s_add_u32 s62, s62, s61
    s_lshl_b32 s62, s62, 7
    s_add_u32 s62, s62, 2097152
    s_waitcnt lgkmcnt(0)
    s_mov_b32 exec_lo, 0xffffffff
    s_mov_b32 exec_hi, 0xffff
    buffer_store_dwordx2 v[16:17], v7, s[40:43], s62 offen sc1
    s_mov_b64 exec, -1
    s_lshl_b32 s63, s34, 2
    s_add_u32 s63, s63, 2
    s_lshl_b32 s63, s63, 9
    s_add_u32 s63, s63, 917504
    v_lshlrev_b32 v6, 4, v1
    s_mov_b32 exec_lo, -1
    s_mov_b32 exec_hi, 0
    s_branch Lpoll_177
Lpollr_178:
    s_sleep 8
    s_sub_u32 s96, s96, 1
    s_cbranch_scc1 Labort
Lpoll_177:
    buffer_load_dwordx4 v[12:15], v6, s[40:43], s63 offen sc1
    s_waitcnt vmcnt(0)
    v_xor_b32 v28, s32, v13
    v_xor_b32 v29, s32, v15
    v_or_b32 v28, v28, v29
    v_cmp_ne_u32 vcc, 0, v28
    s_nop 1
    s_cbranch_vccnz Lpollr_178
Lpolld_179:
    s_mov_b64 exec, -1
    v_cmp_gt_u32 vcc, 32, v1
    v_mov_b32 v6, 0xff800000
    v_mov_b32 v7, 0
    s_nop 0
    v_cndmask_b32 v12, v6, v12, vcc
    v_cndmask_b32 v14, v7, v14, vcc
    v_mov_b32 v6, v12
    s_nop 1
    v_max_f32_dpp v6, v6, v6 row_ror:8 row_mask:0xf bank_mask:0xf
    s_nop 1
    v_max_f32_dpp v6, v6, v6 row_ror:4 row_mask:0xf bank_mask:0xf
    s_nop 1
    v_max_f32_dpp v6, v6, v6 row_ror:2 row_mask:0xf bank_mask:0xf
    s_nop 1
    v_max_f32_dpp v6, v6, v6 row_ror:1 row_mask:0xf bank_mask:0xf
    v_mov_b32 v8, v6
    s_nop 1
    v_permlane16_swap_b32 v8, v6
    v_max_f32 v6, v8, v6
    v_mov_b32 v8, v6
    s_nop 1
    v_permlane32_swap_b32 v8, v6
    v_max_f32 v6, v8, v6
    v_sub_f32 v7, v12, v6
    v_mul_f32 v7, 0x3fb8aa3b, v7
    v_exp_f32 v7, v7
    s_nop 0
    v_mul_f32 v7, v7, v14
    s_nop 1
    v_add_f32_dpp v7, v7, v7 row_ror:8 row_mask:0xf bank_mask:0xf
    s_nop 1
    v_add_f32_dpp v7, v7, v7 row_ror:4 row_mask:0xf bank_mask:0xf
    s_nop 1
    v_add_f32_dpp v7, v7, v7 row_ror:2 row_mask:0xf bank_mask:0xf
    s_nop 1
    v_add_f32_dpp v7, v7, v7 row_ror:1 row_mask:0xf bank_mask:0xf
    v_mov_b32 v8, v7
    s_nop 1
    v_permlane16_swap_b32 v8, v7
    v_add_f32 v7, v8, v7
    v_mov_b32 v8, v7
    s_nop 1
    v_permlane32_swap_b32 v8, v7
    v_add_f32 v7, v8, v7
    v_rcp_f32 v7, v7
    s_nop 1
    v_readfirstlane_b32 s92, v6
    v_readfirstlane_b32 s93, v7
    s_add_u32 s62, s95, 512
    v_lshlrev_b32 v6, 2, v1
    v_add_u32 v6, s62, v6
    ds_read_b32 v12, v6
    s_waitcnt lgkmcnt(0)
    v_lshlrev_b32 v14, 16, v12
    v_and_b32 v15, 0xffff0000, v12
    v_subrev_f32 v14, s92, v14
    v_subrev_f32 v15, s92, v15
    v_mul_f32 v14, 0x3fb8aa3b, v14
    v_mul_f32 v15, 0x3fb8aa3b, v15
    v_exp_f32 v14, v14
    v_exp_f32 v15, v15
    s_nop 0
    v_mul_f32 v14, s93, v14
    v_mul_f32 v15, s93, v15
    v_cvt_pk_bf16_f32 v12, v14, v15
    v_mov_b32 v7, 3
    ds_write_b32 v6, v12
    s_mov_b64 exec, 1
    ds_write_b32 v2, v7 offset:48
    s_mov_b64 exec, -1
Lw_180:
    ds_read_b32 v8, v9 offset:24
    s_waitcnt lgkmcnt(0)
    v_readfirstlane_b32 s90, v8
    s_nop 0
    s_cmp_ge_u32 s90, 1
    s_cbranch_scc1 Lwd_181
    s_sleep 4
    s_sub_u32 s96, s96, 1
    s_cbranch_scc1 Labort
    s_branch Lw_180
Lwd_181:
    s_lshl_b32 s63, s34, 2
    s_add_u32 s63, s63, 3
    s_lshl_b32 s63, s63, 9
    s_add_u32 s63, s63, 917504
    v_lshlrev_b32 v6, 4, v1
    s_mov_b32 exec_lo, -1
    s_mov_b32 exec_hi, 0
    s_branch Lpoll_182
Lpollr_183:
    s_sleep 8
    s_sub_u32 s96, s96, 1
    s_cbranch_scc1 Labort
Lpoll_182:
    buffer_load_dwordx4 v[12:15], v6, s[40:43], s63 offen sc1
    s_waitcnt vmcnt(0)
    v_xor_b32 v28, s32, v13
    v_xor_b32 v29, s32, v15
    v_or_b32 v28, v28, v29
    v_cmp_ne_u32 vcc, 0, v28
    s_nop 1
    s_cbranch_vccnz Lpollr_183
Lpolld_184:
    s_mov_b64 exec, -1
    v_cmp_gt_u32 vcc, 32, v1
    v_mov_b32 v6, 0xff800000
    v_mov_b32 v7, 0
    s_nop 0
    v_cndmask_b32 v12, v6, v12, vcc
    v_cndmask_b32 v14, v7, v14, vcc
    v_mov_b32 v6, v12
    s_nop 1
    v_max_f32_dpp v6, v6, v6 row_ror:8 row_mask:0xf bank_mask:0xf
    s_nop 1
    v_max_f32_dpp v6, v6, v6 row_ror:4 row_mask:0xf bank_mask:0xf
    s_nop 1
    v_max_f32_dpp v6, v6, v6 row_ror:2 row_mask:0xf bank_mask:0xf
    s_nop 1
    v_max_f32_dpp v6, v6, v6 row_ror:1 row_mask:0xf bank_mask:0xf
    v_mov_b32 v8, v6
    s_nop 1
    v_permlane16_swap_b32 v8, v6
    v_max_f32 v6, v8, v6
    v_mov_b32 v8, v6
    s_nop 1
    v_permlane32_swap_b32 v8, v6
    v_max_f32 v6, v8, v6
    v_sub_f32 v7, v12, v6
    v_mul_f32 v7, 0x3fb8aa3b, v7
    v_exp_f32 v7, v7
    s_nop 0
    v_mul_f32 v7, v7, v14
    s_nop 1
    v_add_f32_dpp v7, v7, v7 row_ror:8 row_mask:0xf bank_mask:0xf
    s_nop 1
    v_add_f32_dpp v7, v7, v7 row_ror:4 row_mask:0xf bank_mask:0xf
    s_nop 1
    v_add_f32_dpp v7, v7, v7 row_ror:2 row_mask:0xf bank_mask:0xf
    s_nop 1
    v_add_f32_dpp v7, v7, v7 row_ror:1 row_mask:0xf bank_mask:0xf
    v_mov_b32 v8, v7
    s_nop 1
    v_permlane16_swap_b32 v8, v7
    v_add_f32 v7, v8, v7
    v_mov_b32 v8, v7
    s_nop 1
    v_permlane32_swap_b32 v8, v7
    v_add_f32 v7, v8, v7
    v_rcp_f32 v7, v7
    s_nop 1
    v_readfirstlane_b32 s92, v6
    v_readfirstlane_b32 s93, v7
    s_add_u32 s62, s95, 768
    v_lshlrev_b32 v6, 2, v1
    v_add_u32 v6, s62, v6
    ds_read_b32 v12, v6
    s_waitcnt lgkmcnt(0)
    v_lshlrev_b32 v14, 16, v12
    v_and_b32 v15, 0xffff0000, v12
    v_subrev_f32 v14, s92, v14
    v_subrev_f32 v15, s92, v15
    v_mul_f32 v14, 0x3fb8aa3b, v14
    v_mul_f32 v15, 0x3fb8aa3b, v15
    v_exp_f32 v14, v14
    v_exp_f32 v15, v15
    s_nop 0
    v_mul_f32 v14, s93, v14
    v_mul_f32 v15, s93, v15
    v_cvt_pk_bf16_f32 v12, v14, v15
    v_mov_b32 v7, 4
    ds_write_b32 v6, v12
    s_mov_b64 exec, 1
    ds_write_b32 v2, v7 offset:48
    s_mov_b64 exec, -1
    s_mov_b32 s60, 0
    s_mov_b32 s59, 0
    s_lshl_b32 s57, s33, 4
    s_add_u32 s94, s57, 162688
    s_add_u32 s57, s57, 162752
    s_lshl_b32 s56, s34, 7
    s_add_u32 s56, s56, 229376
    s_lshl_b32 s61, s34, 14
    s_add_u32 s61, s61, 2097152
    s_lshl_b32 s95, s33, 8
    s_add_u32 s95, s95, 154624
    s_mov_b32 s58, 0
    s_mov_b32 s55, 0
    s_mov_b32 s52, 0
    v_mov_b32 v20, 0
Lpp_185:
    s_and_b32 s62, s60, 3
    s_lshl_b32 s62, s62, 2
    s_add_u32 s62, s62, s94
    v_mov_b32 v6, s62
Lw_187:
    ds_read_b32 v8, v2 offset:80
    s_waitcnt lgkmcnt(0)
    v_readfirstlane_b32 s90, v8
    s_nop 0
    s_cmp_gt_u32 s90, s60
    s_cbranch_scc1 Lwd_188
    s_sleep 1
    s_sub_u32 s96, s96, 1
    s_cbranch_scc1 Labort
    s_branch Lw_187
Lwd_188:
    ds_read_b32 v7, v6
    s_waitcnt lgkmcnt(0)
    v_readfirstlane_b32 s63, v7
    s_nop 0
    s_cmp_ge_u32 s63, 128
    s_cbranch_scc1 Lpe_186
    s_lshl_b32 s63, s63, 7
    s_add_u32 s63, s63, s61
    v_lshlrev_b32 v6, 3, v1
    s_mov_b32 s54, 0
    s_cmp_eq_u32 s55, 0
    s_cbranch_scc0 Lnat_189
    s_mov_b64 exec, 1
    v_mov_b32 v22, 1
    buffer_atomic_add v22, v20, s[40:43], s56 offen sc0 sc1
    s_mov_b32 s54, 1
Lnat_189:
    s_cmp_ge_u32 s60, 1
    s_cbranch_scc0 Lns2_194
    s_mov_b64 exec, 0xffff
    buffer_load_dwordx2 v[12:13], v6, s[40:43], s63 offen sc1
    s_waitcnt vmcnt(1)
    s_branch Lw1_195
Lns2_194:
    s_waitcnt vmcnt(0)
Lw1_195:
    s_mov_b64 exec, 1
    s_cmp_eq_u32 s54, 1
    s_cbranch_scc0 Lnsc_190
    v_readfirstlane_b32 s53, v22
    s_and_b32 s62, s59, 3
    s_lshl_b32 s62, s62, 2
    s_add_u32 s62, s62, s57
    v_mov_b32 v7, s62
    v_mov_b32 v8, s53
    s_add_u32 s59, s59, 1
    v_mov_b32 v14, s59
    ds_write_b32 v7, v8
    ds_write_b32 v2, v14 offset:112
    s_cmp_ge_u32 s53, 96
    s_cselect_b32 s55, 1, s55
Lnsc_190:
    s_cmp_ge_u32 s60, 1
    s_cbranch_scc0 Lnp_193
    s_mov_b64 exec, 0xffff
    s_waitcnt vmcnt(0)
    v_xor_b32 v28, s32, v13
    v_cmp_ne_u32 vcc, 0, v28
    s_nop 1
    s_cbranch_vccnz Lpr_191
    s_branch Lpc_192
Lpr_191:
    s_branch Lpoll_196
Lpollr_197:
    s_sub_u32 s96, s96, 1
    s_cbranch_scc1 Labort
Lpoll_196:
    buffer_load_dwordx2 v[12:13], v6, s[40:43], s63 offen sc1
    s_waitcnt vmcnt(0)
    v_xor_b32 v28, s32, v13
    v_cmp_ne_u32 vcc, 0, v28
    s_nop 1
    s_cbranch_vccnz Lpollr_197
Lpolld_198:
Lpc_192:
    v_lshlrev_b32 v14, 16, v12
    v_and_b32 v15, 0xffff0000, v12
    v_subrev_f32 v14, s92, v14
    v_subrev_f32 v15, s92, v15
    v_mul_f32 v14, 0x3fb8aa3b, v14
    v_mul_f32 v15, 0x3fb8aa3b, v15
    v_exp_f32 v14, v14
    v_exp_f32 v15, v15
    s_nop 0
    v_mul_f32 v14, s93, v14
    v_mul_f32 v15, s93, v15
    v_cvt_pk_bf16_f32 v12, v14, v15
    s_and_b32 s62, s52, 3
    s_lshl_b32 s62, s62, 6
    s_add_u32 s62, s62, s95
    v_lshlrev_b32 v6, 2, v1
    v_add_u32 v6, s62, v6
    s_add_u32 s52, s52, 1
    v_mov_b32 v7, s52
    ds_write_b32 v6, v12
    s_mov_b64 exec, 1
    ds_write_b32 v2, v7 offset:96
Lnp_193:
    s_mov_b64 exec, -1
    s_add_u32 s60, s60, 1
    s_branch Lpp_185
Lpe_186:
    s_mov_b64 exec, -1
    s_cmp_lt_u32 s35, 5
    s_cbranch_scc0 Lhi2_199
    v_and_b32 v6, 15, v1
    v_lshrrev_b32 v7, 2, v6
    v_and_b32 v6, 3, v6
    v_lshl_add_u32 v6, v7, 3, v6
    v_lshlrev_b32 v6, 10, v6
    v_lshrrev_b32 v7, 4, v1
    v_lshl_add_u32 v4, v7, 4, v6
    s_lshl_b32 s62, s34, 15
    s_lshl_b32 s63, s33, 8
    s_add_u32 s62, s62, s63
    s_add_u32 s62, s62, 1048576
    s_add_u32 s63, s62, 4096
    s_lshl_b32 s64, s33, 11
    s_add_u32 s64, s64, 0
    v_lshlrev_b32 v5, 5, v1
    v_add_u32 v5, s64, v5
    v_lshrrev_b32 v6, 4, v1
    s_lshl_b32 s64, s33, 2
    v_add_u32 v6, s64, v6
    v_bfe_u32 v7, v1, 2, 2
    v_and_b32 v8, 3, v1
    v_lshl_add_u32 v9, v7, 4, v6
    v_lshlrev_b32 v9, 5, v9
    v_lshl_add_u32 v9, v8, 3, v9
    v_lshlrev_b32 v6, 13, v7
    v_lshrrev_b32 v7, 4, v1
    v_lshl_add_u32 v7, v7, 2, v8
    v_lshl_add_u32 v10, v7, 4, v6
    s_lshl_b32 s64, s35, 2
    s_add_u32 s64, s64, s33
    s_lshl_b32 s64, s64, 15
    s_lshl_b32 s65, s34, 8
    s_add_u32 s64, s64, s65
    s_add_u32 s64, s64, 262144
    v_mov_b32 v237, s32
    v_mov_b32 v239, s32
    s_mov_b32 s36, 0xfff0fff
    s_mov_b32 s37, 0xfff0fff
    s_mov_b32 s38, 0xfff0fff
    s_mov_b32 s39, 0xfff0fff
Lmg_201:
    s_mov_b64 exec, s[36:37]
    s_cbranch_execz Lmk_203
    buffer_load_dwordx4 v[204:207], v4, s[40:43], s62 offen offset:0 sc1
    buffer_load_dwordx4 v[208:211], v4, s[40:43], s62 offen offset:64 sc1
    buffer_load_dwordx4 v[212:215], v4, s[40:43], s62 offen offset:128 sc1
    buffer_load_dwordx4 v[216:219], v4, s[40:43], s62 offen offset:192 sc1
Lmk_203:
    s_mov_b64 exec, s[38:39]
    s_cbranch_execz Lmk_204
    buffer_load_dwordx4 v[220:223], v4, s[40:43], s63 offen offset:0 sc1
    buffer_load_dwordx4 v[224:227], v4, s[40:43], s63 offen offset:64 sc1
    buffer_load_dwordx4 v[228:231], v4, s[40:43], s63 offen offset:128 sc1
    buffer_load_dwordx4 v[232:235], v4, s[40:43], s63 offen offset:192 sc1
Lmk_204:
    s_mov_b64 exec, -1
    s_waitcnt vmcnt(0)
    v_xor_b32 v28, s32, v207
    v_xor_b32 v29, s32, v211
    v_xor_b32 v30, s32, v215
    v_xor_b32 v31, s32, v219
    v_or3_b32 v28, v28, v29, v30
    v_or_b32 v28, v28, v31
    v_cmp_ne_u32 s[36:37], 0, v28
    s_and_b32 s36, s36, 0xfff0fff
    s_and_b32 s37, s37, 0xfff0fff
    v_xor_b32 v28, s32, v223
    v_xor_b32 v29, s32, v227
    v_xor_b32 v30, s32, v231
    v_xor_b32 v31, s32, v235
    v_or3_b32 v28, v28, v29, v30
    v_or_b32 v28, v28, v31
    v_cmp_ne_u32 s[38:39], 0, v28
    s_and_b32 s38, s38, 0xfff0fff
    s_and_b32 s39, s39, 0xfff0fff
    s_mov_b64 s[90:91], s[36:37]
    s_or_b64 s[90:91], s[90:91], s[38:39]
    s_cmp_eq_u64 s[90:91], 0
    s_cbranch_scc1 Lmgd_202
    s_sleep 8
    s_sub_u32 s96, s96, 1
    s_cbranch_scc1 Labort
    s_branch Lmg_201
Lmgd_202:
Lw_205:
    ds_read_b32 v8, v2 offset:128
    s_waitcnt lgkmcnt(0)
    v_readfirstlane_b32 s90, v8
    s_nop 0
    s_cmp_ge_u32 s90, 1
    s_cbranch_scc1 Lwd_206
    s_sleep 2
    s_sub_u32 s96, s96, 1
    s_cbranch_scc1 Labort
    s_branch Lw_205
Lwd_206:
    s_mov_b32 s36, 0xf000f000
    s_mov_b32 s37, 0xf000f000
    s_mov_b32 s38, 0xf000f000
    s_mov_b32 s39, 0xf000f000
Lmg_207:
    s_mov_b64 exec, s[36:37]
    s_cbranch_execz Lmk_209
    buffer_load_dwordx4 v[204:207], v4, s[40:43], s62 offen offset:0 sc1
    buffer_load_dwordx4 v[208:211], v4, s[40:43], s62 offen offset:64 sc1
    buffer_load_dwordx4 v[212:215], v4, s[40:43], s62 offen offset:128 sc1
    buffer_load_dwordx4 v[216:219], v4, s[40:43], s62 offen offset:192 sc1
Lmk_209:
    s_mov_b64 exec, s[38:39]
    s_cbranch_execz Lmk_210
    buffer_load_dwordx4 v[220:223], v4, s[40:43], s63 offen offset:0 sc1
    buffer_load_dwordx4 v[224:227], v4, s[40:43], s63 offen offset:64 sc1
    buffer_load_dwordx4 v[228:231], v4, s[40:43], s63 offen offset:128 sc1
    buffer_load_dwordx4 v[232:235], v4, s[40:43], s63 offen offset:192 sc1
Lmk_210:
    s_mov_b64 exec, -1
    s_waitcnt vmcnt(0)
    v_xor_b32 v28, s32, v207
    v_xor_b32 v29, s32, v211
    v_xor_b32 v30, s32, v215
    v_xor_b32 v31, s32, v219
    v_or3_b32 v28, v28, v29, v30
    v_or_b32 v28, v28, v31
    v_cmp_ne_u32 s[36:37], 0, v28
    s_and_b32 s36, s36, 0xf000f000
    s_and_b32 s37, s37, 0xf000f000
    v_xor_b32 v28, s32, v223
    v_xor_b32 v29, s32, v227
    v_xor_b32 v30, s32, v231
    v_xor_b32 v31, s32, v235
    v_or3_b32 v28, v28, v29, v30
    v_or_b32 v28, v28, v31
    v_cmp_ne_u32 s[38:39], 0, v28
    s_and_b32 s38, s38, 0xf000f000
    s_and_b32 s39, s39, 0xf000f000
    s_mov_b64 s[90:91], s[36:37]
    s_or_b64 s[90:91], s[90:91], s[38:39]
    s_cmp_eq_u64 s[90:91], 0
    s_cbranch_scc1 Lmgd_208
    s_sub_u32 s96, s96, 1
    s_cbranch_scc1 Labort
    s_branch Lmg_207
Lmgd_208:
    v_add_f32 v16, v204, v220
    v_add_f32 v17, v205, v221
    v_add_f32 v18, v206, v222
    v_add_f32 v19, v208, v224
    v_add_f32 v20, v209, v225
    v_add_f32 v21, v210, v226
    v_add_f32 v22, v212, v228
    v_add_f32 v23, v213, v229
    v_add_f32 v24, v214, v230
    v_add_f32 v25, v216, v232
    v_add_f32 v26, v217, v233
    v_add_f32 v27, v218, v234
    v_add_f32_dpp v16, v16, v16 quad_perm:[1,0,3,2] row_mask:0xf bank_mask:0xf
    v_add_f32_dpp v17, v17, v17 quad_perm:[1,0,3,2] row_mask:0xf bank_mask:0xf
    v_add_f32_dpp v18, v18, v18 quad_perm:[1,0,3,2] row_mask:0xf bank_mask:0xf
    v_add_f32_dpp v19, v19, v19 quad_perm:[1,0,3,2] row_mask:0xf bank_mask:0xf
    v_add_f32_dpp v20, v20, v20 quad_perm:[1,0,3,2] row_mask:0xf bank_mask:0xf
    v_add_f32_dpp v21, v21, v21 quad_perm:[1,0,3,2] row_mask:0xf bank_mask:0xf
    v_add_f32_dpp v22, v22, v22 quad_perm:[1,0,3,2] row_mask:0xf bank_mask:0xf
    v_add_f32_dpp v23, v23, v23 quad_perm:[1,0,3,2] row_mask:0xf bank_mask:0xf
    v_add_f32_dpp v24, v24, v24 quad_perm:[1,0,3,2] row_mask:0xf bank_mask:0xf
    v_add_f32_dpp v25, v25, v25 quad_perm:[1,0,3,2] row_mask:0xf bank_mask:0xf
    v_add_f32_dpp v26, v26, v26 quad_perm:[1,0,3,2] row_mask:0xf bank_mask:0xf
    v_add_f32_dpp v27, v27, v27 quad_perm:[1,0,3,2] row_mask:0xf bank_mask:0xf
    v_add_f32_dpp v16, v16, v16 quad_perm:[2,3,0,1] row_mask:0xf bank_mask:0xf
    v_add_f32_dpp v17, v17, v17 quad_perm:[2,3,0,1] row_mask:0xf bank_mask:0xf
    v_add_f32_dpp v18, v18, v18 quad_perm:[2,3,0,1] row_mask:0xf bank_mask:0xf
    v_add_f32_dpp v19, v19, v19 quad_perm:[2,3,0,1] row_mask:0xf bank_mask:0xf
    v_add_f32_dpp v20, v20, v20 quad_perm:[2,3,0,1] row_mask:0xf bank_mask:0xf
    v_add_f32_dpp v21, v21, v21 quad_perm:[2,3,0,1] row_mask:0xf bank_mask:0xf
    v_add_f32_dpp v22, v22, v22 quad_perm:[2,3,0,1] row_mask:0xf bank_mask:0xf
    v_add_f32_dpp v23, v23, v23 quad_perm:[2,3,0,1] row_mask:0xf bank_mask:0xf
    v_add_f32_dpp v24, v24, v24 quad_perm:[2,3,0,1] row_mask:0xf bank_mask:0xf
    v_add_f32_dpp v25, v25, v25 quad_perm:[2,3,0,1] row_mask:0xf bank_mask:0xf
    v_add_f32_dpp v26, v26, v26 quad_perm:[2,3,0,1] row_mask:0xf bank_mask:0xf
    v_add_f32_dpp v27, v27, v27 quad_perm:[2,3,0,1] row_mask:0xf bank_mask:0xf
    v_cvt_pk_bf16_f32 v28, v16, v17
    v_cvt_pk_bf16_f32 v29, v18, v19
    v_cvt_pk_bf16_f32 v30, v20, v21
    v_cvt_pk_bf16_f32 v31, v22, v23
    v_cvt_pk_bf16_f32 v32, v24, v25
    v_cvt_pk_bf16_f32 v33, v26, v27
    s_nop 0
    v_mfma_f32_16x16x32_bf16 v[204:207], v[28:31], v[132:135], 0
    v_mfma_f32_16x16x32_bf16 v[208:211], v[28:31], v[140:143], 0
    v_mfma_f32_16x16x32_bf16 v[212:215], v[28:31], v[148:151], 0
    v_mfma_f32_16x16x32_bf16 v[216:219], v[28:31], v[156:159], 0
    v_mfma_f32_16x16x32_bf16 v[220:223], v[28:31], v[164:167], 0
    v_mfma_f32_16x16x32_bf16 v[224:227], v[28:31], v[172:175], 0
    v_mfma_f32_16x16x32_bf16 v[228:231], v[28:31], v[180:183], 0
    v_mfma_f32_16x16x32_bf16 v[232:235], v[28:31], v[188:191], 0
    v_mfma_f32_16x16x16_bf16 v[204:207], v[32:33], v[136:137], v[204:207]
    v_mfma_f32_16x16x16_bf16 v[208:211], v[32:33], v[144:145], v[208:211]
    v_mfma_f32_16x16x16_bf16 v[212:215], v[32:33], v[152:153], v[212:215]
    v_mfma_f32_16x16x16_bf16 v[216:219], v[32:33], v[160:161], v[216:219]
    v_mfma_f32_16x16x16_bf16 v[220:223], v[32:33], v[168:169], v[220:223]
    v_mfma_f32_16x16x16_bf16 v[224:227], v[32:33], v[176:177], v[224:227]
    v_mfma_f32_16x16x16_bf16 v[228:231], v[32:33], v[184:185], v[228:231]
    v_mfma_f32_16x16x16_bf16 v[232:235], v[32:33], v[192:193], v[232:235]
    s_nop 1
    v_mov_b32 v16, v204
    v_mov_b32 v17, v208
    v_mov_b32 v18, v212
    v_mov_b32 v19, v216
    v_mov_b32 v20, v220
    v_mov_b32 v21, v224
    v_mov_b32 v22, v228
    v_mov_b32 v23, v232
    ds_write_b128 v5, v[16:19]
    ds_write_b128 v5, v[20:23] offset:16
    s_waitcnt lgkmcnt(0)
    s_barrier
    ds_read_b64 v[16:17], v9 offset:0
    ds_read_b64 v[18:19], v9 offset:2048
    ds_read_b64 v[20:21], v9 offset:4096
    ds_read_b64 v[22:23], v9 offset:6144
    s_waitcnt lgkmcnt(2)
    v_pk_add_f32 v[16:17], v[16:17], v[18:19]
    s_waitcnt lgkmcnt(0)
    v_pk_add_f32 v[20:21], v[20:21], v[22:23]
    v_add_f32 v236, v16, v20
    v_add_f32 v238, v17, v21
    buffer_store_dwordx4 v[236:239], v10, s[40:43], s64 offen sc1
    s_branch Ldone_200
Lhi2_199:
    s_cmp_eq_u32 s69, 2
    s_cbranch_scc0 Lnd_211
    v_mov_b32 v32, v240
    v_lshrrev_b32 v6, 4, v1
    v_mul_u32_u24 v6, 2560, v6
    v_and_b32 v7, 15, v1
    v_lshl_add_u32 v4, v7, 3, v6
    s_lshl_b32 s64, s68, 7
    s_and_b32 s65, s68, 3
    s_mul_i32 s65, s65, 10240
    s_add_u32 s64, s64, s65
    s_add_u32 s64, s64, 983040
    v_add_u32 v6, 0, v1
    v_mul_u32_u24 v7, 683, v6
    v_lshrrev_b32 v7, 16, v7
    v_mul_u32_u24 v8, 96, v7
    v_sub_u32 v8, v6, v8
    v_mul_u32_u24 v7, 6144, v7
    v_lshl_add_u32 v16, v8, 4, v7
    v_add_u32 v6, 64, v1
    v_mul_u32_u24 v7, 683, v6
    v_lshrrev_b32 v7, 16, v7
    v_mul_u32_u24 v8, 96, v7
    v_sub_u32 v8, v6, v8
    v_mul_u32_u24 v7, 6144, v7
    v_lshl_add_u32 v17, v8, 4, v7
    v_add_u32 v6, 128, v1
    v_mul_u32_u24 v7, 683, v6
    v_lshrrev_b32 v7, 16, v7
    v_mul_u32_u24 v8, 96, v7
    v_sub_u32 v8, v6, v8
    v_mul_u32_u24 v7, 6144, v7
    v_lshl_add_u32 v18, v8, 4, v7
    v_add_u32 v6, 192, v1
    v_mul_u32_u24 v7, 683, v6
    v_lshrrev_b32 v7, 16, v7
    v_mul_u32_u24 v8, 96, v7
    v_sub_u32 v8, v6, v8
    v_mul_u32_u24 v7, 6144, v7
    v_lshl_add_u32 v19, v8, 4, v7
    v_add_u32 v6, 256, v1
    v_mul_u32_u24 v7, 683, v6
    v_lshrrev_b32 v7, 16, v7
    v_mul_u32_u24 v8, 96, v7
    v_sub_u32 v8, v6, v8
    v_mul_u32_u24 v7, 6144, v7
    v_lshl_add_u32 v20, v8, 4, v7
    v_add_u32 v6, 320, v1
    v_mul_u32_u24 v7, 683, v6
    v_lshrrev_b32 v7, 16, v7
    v_mul_u32_u24 v8, 96, v7
    v_sub_u32 v8, v6, v8
    v_mul_u32_u24 v7, 6144, v7
    v_lshl_add_u32 v21, v8, 4, v7
    s_mul_i32 s62, s33, 1536
    s_add_u32 s62, s62, 196608
    s_mul_i32 s63, s33, 3072
    s_add_u32 s63, s63, 16384
    v_lshlrev_b32 v6, 3, v1
    v_add_u32 v5, s63, v6
    v_and_b32 v7, 15, v1
    v_lshrrev_b32 v7, 2, v7
    v_mul_u32_u24 v7, 768, v7
    v_lshrrev_b32 v8, 4, v1
    v_lshl_add_u32 v7, v8, 4, v7
    v_add_u32 v9, s63, v7
    s_lshl_b32 s63, s33, 9
    s_add_u32 s63, s63, 8192
    v_add_u32 v10, s63, v6
    v_mov_b32 v11, v6
    v_lshrrev_b32 v6, 4, v1
    v_mul_u32_u24 v6, 1280, v6
    v_and_b32 v7, 15, v1
    v_lshl_add_u32 v12, v7, 2, v6
    s_lshl_b32 s65, s68, 6
    s_mov_b32 s44, s26
    s_and_b32 s45, s27, 0xffff
    s_mov_b32 s46, 5120
    s_mov_b32 s47, 0x20000
Lw_212:
    ds_read_b32 v8, v2 offset:128
    s_waitcnt lgkmcnt(0)
    v_readfirstlane_b32 s90, v8
    s_nop 0
    s_cmp_ge_u32 s90, 1
    s_cbranch_scc1 Lwd_213
    s_sleep 2
    s_sub_u32 s96, s96, 1
    s_cbranch_scc1 Labort
    s_branch Lw_212
Lwd_213:
    s_mov_b32 s58, s62
    s_cmp_eq_u32 s69, 1
    s_cbranch_scc0 Lhc_214
    s_mov_b32 s36, s18
    s_and_b32 s37, s19, 0xffff
    s_mov_b32 s38, 1966080
    s_mov_b32 s39, 0x20000
    s_mul_i32 s62, s33, 160
    v_lshrrev_b32 v6, 4, v1
    v_lshlrev_b32 v6, 3, v6
    v_add_u32 v6, s62, v6
    v_mul_u32_u24 v6, 3072, v6
    v_and_b32 v7, 15, v1
    v_lshl_add_u32 v6, v7, 2, v6
    s_lshl_b32 s62, s68, 6
    v_add_u32 v6, s62, v6
    s_mov_b32 s62, 0
    buffer_load_dword v92, v6, s[36:39], s62 offen nt
    s_mov_b32 s62, 3072
    buffer_load_dword v93, v6, s[36:39], s62 offen nt
    s_mov_b32 s62, 6144
    buffer_load_dword v94, v6, s[36:39], s62 offen nt
    s_mov_b32 s62, 9216
    buffer_load_dword v95, v6, s[36:39], s62 offen nt
    s_mov_b32 s62, 12288
    buffer_load_dword v96, v6, s[36:39], s62 offen nt
    s_mov_b32 s62, 15360
    buffer_load_dword v97, v6, s[36:39], s62 offen nt
    s_mov_b32 s62, 18432
    buffer_load_dword v98, v6, s[36:39], s62 offen nt
    s_mov_b32 s62, 21504
    buffer_load_dword v99, v6, s[36:39], s62 offen nt
    s_mov_b32 s62, 98304
    buffer_load_dword v100, v6, s[36:39], s62 offen nt
    s_mov_b32 s62, 101376
    buffer_load_dword v101, v6, s[36:39], s62 offen nt
    s_mov_b32 s62, 104448
    buffer_load_dword v102, v6, s[36:39], s62 offen nt
    s_mov_b32 s62, 107520
    buffer_load_dword v103, v6, s[36:39], s62 offen nt
    s_mov_b32 s62, 110592
    buffer_load_dword v104, v6, s[36:39], s62 offen nt
    s_mov_b32 s62, 113664
    buffer_load_dword v105, v6, s[36:39], s62 offen nt
    s_mov_b32 s62, 116736
    buffer_load_dword v106, v6, s[36:39], s62 offen nt
    s_mov_b32 s62, 119808
    buffer_load_dword v107, v6, s[36:39], s62 offen nt
    s_mov_b32 s62, 196608
    buffer_load_dword v108, v6, s[36:39], s62 offen nt
    s_mov_b32 s62, 199680
    buffer_load_dword v109, v6, s[36:39], s62 offen nt
    s_mov_b32 s62, 202752
    buffer_load_dword v110, v6, s[36:39], s62 offen nt
    s_mov_b32 s62, 205824
    buffer_load_dword v111, v6, s[36:39], s62 offen nt
    s_mov_b32 s62, 208896
    buffer_load_dword v112, v6, s[36:39], s62 offen nt
    s_mov_b32 s62, 211968
    buffer_load_dword v113, v6, s[36:39], s62 offen nt
    s_mov_b32 s62, 215040
    buffer_load_dword v114, v6, s[36:39], s62 offen nt
    s_mov_b32 s62, 218112
    buffer_load_dword v115, v6, s[36:39], s62 offen nt
    s_mov_b32 s62, 294912
    buffer_load_dword v116, v6, s[36:39], s62 offen nt
    s_mov_b32 s62, 297984
    buffer_load_dword v117, v6, s[36:39], s62 offen nt
    s_mov_b32 s62, 301056
    buffer_load_dword v118, v6, s[36:39], s62 offen nt
    s_mov_b32 s62, 304128
    buffer_load_dword v119, v6, s[36:39], s62 offen nt
    s_mov_b32 s62, 307200
    buffer_load_dword v120, v6, s[36:39], s62 offen nt
    s_mov_b32 s62, 310272
    buffer_load_dword v121, v6, s[36:39], s62 offen nt
    s_mov_b32 s62, 313344
    buffer_load_dword v122, v6, s[36:39], s62 offen nt
    s_mov_b32 s62, 316416
    buffer_load_dword v123, v6, s[36:39], s62 offen nt
    s_mov_b32 s62, 393216
    buffer_load_dword v124, v6, s[36:39], s62 offen nt
    s_mov_b32 s62, 396288
    buffer_load_dword v125, v6, s[36:39], s62 offen nt
    s_mov_b32 s62, 399360
    buffer_load_dword v126, v6, s[36:39], s62 offen nt
    s_mov_b32 s62, 402432
    buffer_load_dword v127, v6, s[36:39], s62 offen nt
    s_mov_b32 s62, 405504
    buffer_load_dword v128, v6, s[36:39], s62 offen nt
    s_mov_b32 s62, 408576
    buffer_load_dword v129, v6, s[36:39], s62 offen nt
    s_mov_b32 s62, 411648
    buffer_load_dword v130, v6, s[36:39], s62 offen nt
    s_mov_b32 s62, 414720
    buffer_load_dword v131, v6, s[36:39], s62 offen nt
    s_waitcnt vmcnt(0)
    v_perm_b32 v84, v93, v92, s97
    v_perm_b32 v85, v95, v94, s97
    v_perm_b32 v86, v97, v96, s97
    v_perm_b32 v87, v99, v98, s97
    v_perm_b32 v88, v93, v92, s98
    v_perm_b32 v89, v95, v94, s98
    v_perm_b32 v90, v97, v96, s98
    v_perm_b32 v91, v99, v98, s98
    v_perm_b32 v92, v101, v100, s97
    v_perm_b32 v93, v103, v102, s97
    v_perm_b32 v94, v105, v104, s97
    v_perm_b32 v95, v107, v106, s97
    v_perm_b32 v96, v101, v100, s98
    v_perm_b32 v97, v103, v102, s98
    v_perm_b32 v98, v105, v104, s98
    v_perm_b32 v99, v107, v106, s98
    v_perm_b32 v100, v109, v108, s97
    v_perm_b32 v101, v111, v110, s97
    v_perm_b32 v102, v113, v112, s97
    v_perm_b32 v103, v115, v114, s97
    v_perm_b32 v104, v109, v108, s98
    v_perm_b32 v105, v111, v110, s98
    v_perm_b32 v106, v113, v112, s98
    v_perm_b32 v107, v115, v114, s98
    v_perm_b32 v108, v117, v116, s97
    v_perm_b32 v109, v119, v118, s97
    v_perm_b32 v110, v121, v120, s97
    v_perm_b32 v111, v123, v122, s97
    v_perm_b32 v112, v117, v116, s98
    v_perm_b32 v113, v119, v118, s98
    v_perm_b32 v114, v121, v120, s98
    v_perm_b32 v115, v123, v122, s98
    v_perm_b32 v116, v125, v124, s97
    v_perm_b32 v117, v127, v126, s97
    v_perm_b32 v118, v129, v128, s97
    v_perm_b32 v119, v131, v130, s97
    v_perm_b32 v120, v125, v124, s98
    v_perm_b32 v121, v127, v126, s98
    v_perm_b32 v122, v129, v128, s98
    v_perm_b32 v123, v131, v130, s98
Lhc_214:
    s_cmp_eq_u32 s69, 2
    s_cbranch_scc0 Lhd_215
    s_mov_b32 s36, s20
    s_and_b32 s37, s21, 0xffff
    s_mov_b32 s38, 1966080
    s_mov_b32 s39, 0x20000
    s_mul_i32 s62, s33, 384
    v_lshrrev_b32 v6, 4, v1
    v_lshlrev_b32 v6, 3, v6
    v_add_u32 v6, s62, v6
    v_mul_u32_u24 v6, 1280, v6
    v_and_b32 v7, 15, v1
    v_lshl_add_u32 v6, v7, 2, v6
    s_lshl_b32 s62, s68, 6
    v_add_u32 v6, s62, v6
    s_mov_b32 s62, 245760
    buffer_load_dword v156, v6, s[36:39], s62 offen nt
    s_mov_b32 s62, 247040
    buffer_load_dword v157, v6, s[36:39], s62 offen nt
    s_mov_b32 s62, 248320
    buffer_load_dword v158, v6, s[36:39], s62 offen nt
    s_mov_b32 s62, 249600
    buffer_load_dword v159, v6, s[36:39], s62 offen nt
    s_mov_b32 s62, 250880
    buffer_load_dword v160, v6, s[36:39], s62 offen nt
    s_mov_b32 s62, 252160
    buffer_load_dword v161, v6, s[36:39], s62 offen nt
    s_mov_b32 s62, 253440
    buffer_load_dword v162, v6, s[36:39], s62 offen nt
    s_mov_b32 s62, 254720
    buffer_load_dword v163, v6, s[36:39], s62 offen nt
    s_mov_b32 s62, 286720
    buffer_load_dword v164, v6, s[36:39], s62 offen nt
    s_mov_b32 s62, 288000
    buffer_load_dword v165, v6, s[36:39], s62 offen nt
    s_mov_b32 s62, 289280
    buffer_load_dword v166, v6, s[36:39], s62 offen nt
    s_mov_b32 s62, 290560
    buffer_load_dword v167, v6, s[36:39], s62 offen nt
    s_mov_b32 s62, 291840
    buffer_load_dword v168, v6, s[36:39], s62 offen nt
    s_mov_b32 s62, 293120
    buffer_load_dword v169, v6, s[36:39], s62 offen nt
    s_mov_b32 s62, 294400
    buffer_load_dword v170, v6, s[36:39], s62 offen nt
    s_mov_b32 s62, 295680
    buffer_load_dword v171, v6, s[36:39], s62 offen nt
    s_mov_b32 s62, 327680
    buffer_load_dword v172, v6, s[36:39], s62 offen nt
    s_mov_b32 s62, 328960
    buffer_load_dword v173, v6, s[36:39], s62 offen nt
    s_mov_b32 s62, 330240
    buffer_load_dword v174, v6, s[36:39], s62 offen nt
    s_mov_b32 s62, 331520
    buffer_load_dword v175, v6, s[36:39], s62 offen nt
    s_mov_b32 s62, 332800
    buffer_load_dword v176, v6, s[36:39], s62 offen nt
    s_mov_b32 s62, 334080
    buffer_load_dword v177, v6, s[36:39], s62 offen nt
    s_mov_b32 s62, 335360
    buffer_load_dword v178, v6, s[36:39], s62 offen nt
    s_mov_b32 s62, 336640
    buffer_load_dword v179, v6, s[36:39], s62 offen nt
    s_mov_b32 s62, 368640
    buffer_load_dword v180, v6, s[36:39], s62 offen nt
    s_mov_b32 s62, 369920
    buffer_load_dword v181, v6, s[36:39], s62 offen nt
    s_mov_b32 s62, 371200
    buffer_load_dword v182, v6, s[36:39], s62 offen nt
    s_mov_b32 s62, 372480
    buffer_load_dword v183, v6, s[36:39], s62 offen nt
    s_mov_b32 s62, 373760
    buffer_load_dword v184, v6, s[36:39], s62 offen nt
    s_mov_b32 s62, 375040
    buffer_load_dword v185, v6, s[36:39], s62 offen nt
    s_mov_b32 s62, 376320
    buffer_load_dword v186, v6, s[36:39], s62 offen nt
    s_mov_b32 s62, 377600
    buffer_load_dword v187, v6, s[36:39], s62 offen nt
    s_mov_b32 s62, 409600
    buffer_load_dword v188, v6, s[36:39], s62 offen nt
    s_mov_b32 s62, 410880
    buffer_load_dword v189, v6, s[36:39], s62 offen nt
    s_mov_b32 s62, 412160
    buffer_load_dword v190, v6, s[36:39], s62 offen nt
    s_mov_b32 s62, 413440
    buffer_load_dword v191, v6, s[36:39], s62 offen nt
    s_mov_b32 s62, 414720
    buffer_load_dword v192, v6, s[36:39], s62 offen nt
    s_mov_b32 s62, 416000
    buffer_load_dword v193, v6, s[36:39], s62 offen nt
    s_mov_b32 s62, 417280
    buffer_load_dword v194, v6, s[36:39], s62 offen nt
    s_mov_b32 s62, 418560
    buffer_load_dword v195, v6, s[36:39], s62 offen nt
    s_mov_b32 s62, 450560
    buffer_load_dword v196, v6, s[36:39], s62 offen nt
    s_mov_b32 s62, 451840
    buffer_load_dword v197, v6, s[36:39], s62 offen nt
    s_mov_b32 s62, 453120
    buffer_load_dword v198, v6, s[36:39], s62 offen nt
    s_mov_b32 s62, 454400
    buffer_load_dword v199, v6, s[36:39], s62 offen nt
    s_mov_b32 s62, 455680
    buffer_load_dword v200, v6, s[36:39], s62 offen nt
    s_mov_b32 s62, 456960
    buffer_load_dword v201, v6, s[36:39], s62 offen nt
    s_mov_b32 s62, 458240
    buffer_load_dword v202, v6, s[36:39], s62 offen nt
    s_mov_b32 s62, 459520
    buffer_load_dword v203, v6, s[36:39], s62 offen nt
    s_waitcnt vmcnt(0)
    v_perm_b32 v148, v157, v156, s97
    v_perm_b32 v149, v159, v158, s97
    v_perm_b32 v150, v161, v160, s97
    v_perm_b32 v151, v163, v162, s97
    v_perm_b32 v152, v157, v156, s98
    v_perm_b32 v153, v159, v158, s98
    v_perm_b32 v154, v161, v160, s98
    v_perm_b32 v155, v163, v162, s98
    v_perm_b32 v156, v165, v164, s97
    v_perm_b32 v157, v167, v166, s97
    v_perm_b32 v158, v169, v168, s97
    v_perm_b32 v159, v171, v170, s97
    v_perm_b32 v160, v165, v164, s98
    v_perm_b32 v161, v167, v166, s98
    v_perm_b32 v162, v169, v168, s98
    v_perm_b32 v163, v171, v170, s98
    v_perm_b32 v164, v173, v172, s97
    v_perm_b32 v165, v175, v174, s97
    v_perm_b32 v166, v177, v176, s97
    v_perm_b32 v167, v179, v178, s97
    v_perm_b32 v168, v173, v172, s98
    v_perm_b32 v169, v175, v174, s98
    v_perm_b32 v170, v177, v176, s98
    v_perm_b32 v171, v179, v178, s98
    v_perm_b32 v172, v181, v180, s97
    v_perm_b32 v173, v183, v182, s97
    v_perm_b32 v174, v185, v184, s97
    v_perm_b32 v175, v187, v186, s97
    v_perm_b32 v176, v181, v180, s98
    v_perm_b32 v177, v183, v182, s98
    v_perm_b32 v178, v185, v184, s98
    v_perm_b32 v179, v187, v186, s98
    v_perm_b32 v180, v189, v188, s97
    v_perm_b32 v181, v191, v190, s97
    v_perm_b32 v182, v193, v192, s97
    v_perm_b32 v183, v195, v194, s97
    v_perm_b32 v184, v189, v188, s98
    v_perm_b32 v185, v191, v190, s98
    v_perm_b32 v186, v193, v192, s98
    v_perm_b32 v187, v195, v194, s98
    v_perm_b32 v188, v197, v196, s97
    v_perm_b32 v189, v199, v198, s97
    v_perm_b32 v190, v201, v200, s97
    v_perm_b32 v191, v203, v202, s97
    v_perm_b32 v192, v197, v196, s98
    v_perm_b32 v193, v199, v198, s98
    v_perm_b32 v194, v201, v200, s98
    v_perm_b32 v195, v203, v202, s98
Lhd_215:
    s_mov_b32 s62, s58
    s_branch Lpoll_216
Lpollr_217:
    s_sleep 3
    s_sub_u32 s96, s96, 1
    s_cbranch_scc1 Labort
Lpoll_216:
    buffer_load_dwordx2 v[34:35], v4, s[40:43], s64 offen sc1
    s_waitcnt vmcnt(0)
    v_xor_b32 v28, s32, v35
    v_cmp_ne_u32 vcc, 0, v28
    s_nop 1
    s_cbranch_vccnz Lpollr_217
Lpolld_218:
    s_cmp_eq_u32 s68, 0
    s_cbranch_scc0 Lep_219
    s_cmp_eq_u32 s33, 0
    s_cbranch_scc0 Lep_219
    v_mov_b32 v6, 0
    v_mov_b32 v7, s32
    s_mov_b64 exec, 1
    buffer_store_dword v7, v6, s[40:43], 0 offen sc1
    s_mov_b64 exec, -1
Lep_219:
    s_branch Lpoll_220
Lpollr_221:
    s_sub_u32 s96, s96, 1
    s_cbranch_scc1 Labort
Lpoll_220:
    buffer_load_dwordx4 v[204:207], v16, s[40:43], s62 offen sc1
    s_waitcnt vmcnt(0)
    v_xor_b32 v28, s32, v205
    v_xor_b32 v29, s32, v207
    v_or_b32 v28, v28, v29
    v_cmp_ne_u32 vcc, 0, v28
    s_nop 1
    s_cbranch_vccnz Lpollr_221
Lpolld_222:
    s_branch Lpoll_223
Lpollr_224:
    s_sub_u32 s96, s96, 1
    s_cbranch_scc1 Labort
Lpoll_223:
    buffer_load_dwordx4 v[208:211], v17, s[40:43], s62 offen sc1
    buffer_load_dwordx4 v[212:215], v18, s[40:43], s62 offen sc1
    buffer_load_dwordx4 v[216:219], v19, s[40:43], s62 offen sc1
    buffer_load_dwordx4 v[220:223], v20, s[40:43], s62 offen sc1
    buffer_load_dwordx4 v[224:227], v21, s[40:43], s62 offen sc1
    s_waitcnt vmcnt(0)
    v_xor_b32 v28, s32, v209
    v_xor_b32 v29, s32, v211
    v_xor_b32 v30, s32, v213
    v_or3_b32 v28, v28, v29, v30
    v_xor_b32 v29, s32, v215
    v_xor_b32 v30, s32, v217
    v_or3_b32 v28, v28, v29, v30
    v_xor_b32 v29, s32, v219
    v_xor_b32 v30, s32, v221
    v_or3_b32 v28, v28, v29, v30
    v_xor_b32 v29, s32, v223
    v_xor_b32 v30, s32, v225
    v_or3_b32 v28, v28, v29, v30
    v_xor_b32 v29, s32, v227
    v_or_b32 v28, v28, v29
    v_cmp_ne_u32 vcc, 0, v28
    s_nop 1
    s_cbranch_vccnz Lpollr_224
Lpolld_225:
    v_mov_b32 v205, v206
    ds_write_b64 v5, v[204:205] offset:0
    v_mov_b32 v209, v210
    ds_write_b64 v5, v[208:209] offset:512
    v_mov_b32 v213, v214
    ds_write_b64 v5, v[212:213] offset:1024
    v_mov_b32 v217, v218
    ds_write_b64 v5, v[216:217] offset:1536
    v_mov_b32 v221, v222
    ds_write_b64 v5, v[220:221] offset:2048
    v_mov_b32 v225, v226
    ds_write_b64 v5, v[224:225] offset:2560
    ds_read_b128 v[36:39], v9 offset:0
    ds_read_b128 v[40:43], v9 offset:64
    ds_read_b128 v[44:47], v9 offset:128
    ds_read_b128 v[48:51], v9 offset:192
    ds_read_b128 v[52:55], v9 offset:256
    ds_read_b128 v[56:59], v9 offset:320
    ds_read_b128 v[60:63], v9 offset:384
    ds_read_b128 v[64:67], v9 offset:448
    ds_read_b128 v[68:71], v9 offset:512
    s_waitcnt lgkmcnt(8)
    v_mfma_f32_16x16x32_bf16 v[24:27], v[36:39], v[100:103], 0
    v_mfma_f32_16x16x32_bf16 v[28:31], v[36:39], v[104:107], 0
    ds_read_b128 v[72:75], v9 offset:576
    s_waitcnt lgkmcnt(8)
    v_mfma_f32_16x16x32_bf16 v[24:27], v[40:43], v[108:111], v[24:27]
    v_mfma_f32_16x16x32_bf16 v[28:31], v[40:43], v[112:115], v[28:31]
    ds_read_b128 v[76:79], v9 offset:640
    s_waitcnt lgkmcnt(8)
    v_mfma_f32_16x16x32_bf16 v[24:27], v[44:47], v[116:119], v[24:27]
    v_mfma_f32_16x16x32_bf16 v[28:31], v[44:47], v[120:123], v[28:31]
    ds_read_b128 v[80:83], v9 offset:704
    s_waitcnt lgkmcnt(8)
    v_mfma_f32_16x16x32_bf16 v[24:27], v[48:51], v[124:127], v[24:27]
    v_mfma_f32_16x16x32_bf16 v[28:31], v[48:51], v[128:131], v[28:31]
    s_waitcnt lgkmcnt(7)
    v_mfma_f32_16x16x32_bf16 v[24:27], v[52:55], v[132:135], v[24:27]
    v_mfma_f32_16x16x32_bf16 v[28:31], v[52:55], v[136:139], v[28:31]
    s_waitcnt lgkmcnt(6)
    v_mfma_f32_16x16x32_bf16 v[24:27], v[56:59], v[140:143], v[24:27]
    v_mfma_f32_16x16x32_bf16 v[28:31], v[56:59], v[144:147], v[28:31]
    s_waitcnt lgkmcnt(5)
    v_mfma_f32_16x16x32_bf16 v[24:27], v[60:63], v[148:151], v[24:27]
    v_mfma_f32_16x16x32_bf16 v[28:31], v[60:63], v[152:155], v[28:31]
    s_waitcnt lgkmcnt(4)
    v_mfma_f32_16x16x32_bf16 v[24:27], v[64:67], v[156:159], v[24:27]
    v_mfma_f32_16x16x32_bf16 v[28:31], v[64:67], v[160:163], v[28:31]
    s_waitcnt lgkmcnt(3)
    v_mfma_f32_16x16x32_bf16 v[24:27], v[68:71], v[164:167], v[24:27]
    v_mfma_f32_16x16x32_bf16 v[28:31], v[68:71], v[168:171], v[28:31]
    s_waitcnt lgkmcnt(2)
    v_mfma_f32_16x16x32_bf16 v[24:27], v[72:75], v[172:175], v[24:27]
    v_mfma_f32_16x16x32_bf16 v[28:31], v[72:75], v[176:179], v[28:31]
    s_waitcnt lgkmcnt(1)
    v_mfma_f32_16x16x32_bf16 v[24:27], v[76:79], v[180:183], v[24:27]
    v_mfma_f32_16x16x32_bf16 v[28:31], v[76:79], v[184:187], v[28:31]
    s_waitcnt lgkmcnt(0)
    v_mfma_f32_16x16x32_bf16 v[24:27], v[80:83], v[188:191], v[24:27]
    v_mfma_f32_16x16x32_bf16 v[28:31], v[80:83], v[192:195], v[28:31]
    s_nop 7
    v_mov_b32 v25, v28
    ds_write_b64 v10, v[24:25]
    s_waitcnt lgkmcnt(0)
    s_barrier
    s_cmp_eq_u32 s33, 0
    s_cbranch_scc0 Ldone_200
    ds_read_b64 v[16:17], v11 offset:8192
    ds_read_b64 v[18:19], v11 offset:8704
    ds_read_b64 v[20:21], v11 offset:9216
    ds_read_b64 v[22:23], v11 offset:9728
    v_lshlrev_b32 v24, 16, v32
    v_and_b32 v25, 0xffff0000, v32
    v_lshlrev_b32 v26, 16, v34
    v_and_b32 v27, 0xffff0000, v34
    s_waitcnt lgkmcnt(2)
    v_pk_add_f32 v[16:17], v[16:17], v[18:19]
    s_waitcnt lgkmcnt(0)
    v_pk_add_f32 v[20:21], v[20:21], v[22:23]
    v_pk_add_f32 v[16:17], v[16:17], v[20:21]
    v_cvt_pk_bf16_f32 v28, v16, v17
    v_lshlrev_b32 v16, 16, v28
    v_and_b32 v17, 0xffff0000, v28
    v_pk_mul_f32 v[16:17], v[16:17], v[24:25]
    v_cvt_pk_bf16_f32 v28, v16, v17
    v_lshlrev_b32 v16, 16, v28
    v_and_b32 v17, 0xffff0000, v28
    v_pk_add_f32 v[16:17], v[16:17], v[26:27]
    v_cvt_pk_bf16_f32 v16, v16, v17
    buffer_store_dword v16, v12, s[44:47], s65 offen
    s_branch Ldone_200
Lnd_211:
    s_cmp_eq_u32 s70, 1
    s_cbranch_scc0 Lnr2_226
    v_lshlrev_b32 v4, 4, v1
    s_lshl_b32 s62, s71, 13
    s_add_u32 s62, s62, 262144
    s_add_u32 s63, s62, 4096
    v_lshrrev_b32 v6, 4, v1
    v_mul_u32_u24 v6, 10240, v6
    v_and_b32 v7, 15, v1
    v_lshl_add_u32 v5, v7, 3, v6
    s_and_b32 s64, s71, 3
    s_mul_i32 s64, s64, 2560
    s_lshr_b32 s65, s71, 2
    s_lshl_b32 s65, s65, 7
    s_add_u32 s64, s64, s65
    s_add_u32 s64, s64, 983040
    v_mov_b32 v21, s32
    v_lshlrev_b32 v24, 16, v182
    v_and_b32 v25, 0xffff0000, v182
    v_lshlrev_b32 v26, 16, v180
    v_and_b32 v27, 0xffff0000, v180
Lw_227:
    ds_read_b32 v8, v2 offset:128
    s_waitcnt lgkmcnt(0)
    v_readfirstlane_b32 s90, v8
    s_nop 0
    s_cmp_ge_u32 s90, 1
    s_cbranch_scc1 Lwd_228
    s_sleep 2
    s_sub_u32 s96, s96, 1
    s_cbranch_scc1 Labort
    s_branch Lw_227
Lwd_228:
    s_mov_b64 s[36:37], -1
    s_mov_b64 s[38:39], -1
    s_mov_b64 s[44:45], -1
    s_mov_b64 s[46:47], -1
Lmg_229:
    s_mov_b64 exec, s[36:37]
    s_cbranch_execz Lmk_231
    buffer_load_dwordx4 v[184:187], v4, s[40:43], s62 offen offset:0 sc1
    buffer_load_dwordx4 v[188:191], v4, s[40:43], s62 offen offset:1024 sc1
Lmk_231:
    s_mov_b64 exec, s[38:39]
    s_cbranch_execz Lmk_232
    buffer_load_dwordx4 v[192:195], v4, s[40:43], s62 offen offset:2048 sc1
    buffer_load_dwordx4 v[196:199], v4, s[40:43], s62 offen offset:3072 sc1
Lmk_232:
    s_mov_b64 exec, s[44:45]
    s_cbranch_execz Lmk_233
    buffer_load_dwordx4 v[200:203], v4, s[40:43], s63 offen offset:0 sc1
    buffer_load_dwordx4 v[204:207], v4, s[40:43], s63 offen offset:1024 sc1
Lmk_233:
    s_mov_b64 exec, s[46:47]
    s_cbranch_execz Lmk_234
    buffer_load_dwordx4 v[208:211], v4, s[40:43], s63 offen offset:2048 sc1
    buffer_load_dwordx4 v[212:215], v4, s[40:43], s63 offen offset:3072 sc1
Lmk_234:
    s_mov_b64 exec, -1
    s_waitcnt vmcnt(0)
    v_xor_b32 v28, s32, v185
    v_xor_b32 v29, s32, v187
    v_xor_b32 v30, s32, v189
    v_xor_b32 v31, s32, v191
    v_or3_b32 v28, v28, v29, v30
    v_or_b32 v28, v28, v31
    v_cmp_ne_u32 s[36:37], 0, v28
    v_xor_b32 v28, s32, v193
    v_xor_b32 v29, s32, v195
    v_xor_b32 v30, s32, v197
    v_xor_b32 v31, s32, v199
    v_or3_b32 v28, v28, v29, v30
    v_or_b32 v28, v28, v31
    v_cmp_ne_u32 s[38:39], 0, v28
    v_xor_b32 v28, s32, v201
    v_xor_b32 v29, s32, v203
    v_xor_b32 v30, s32, v205
    v_xor_b32 v31, s32, v207
    v_or3_b32 v28, v28, v29, v30
    v_or_b32 v28, v28, v31
    v_cmp_ne_u32 s[44:45], 0, v28
    v_xor_b32 v28, s32, v209
    v_xor_b32 v29, s32, v211
    v_xor_b32 v30, s32, v213
    v_xor_b32 v31, s32, v215
    v_or3_b32 v28, v28, v29, v30
    v_or_b32 v28, v28, v31
    v_cmp_ne_u32 s[46:47], 0, v28
    s_mov_b64 s[90:91], s[36:37]
    s_or_b64 s[90:91], s[90:91], s[38:39]
    s_or_b64 s[90:91], s[90:91], s[44:45]
    s_or_b64 s[90:91], s[90:91], s[46:47]
    s_cmp_eq_u64 s[90:91], 0
    s_cbranch_scc1 Lmgd_230
    s_sub_u32 s96, s96, 1
    s_cbranch_scc1 Labort
    s_branch Lmg_229
Lmgd_230:
    v_add_f32 v16, v184, v188
    v_add_f32 v17, v186, v190
    v_add_f32 v18, v192, v196
    v_add_f32 v19, v194, v198
    v_add_f32 v16, v16, v200
    v_add_f32 v17, v17, v202
    v_add_f32 v18, v18, v208
    v_add_f32 v19, v19, v210
    v_add_f32 v16, v16, v204
    v_add_f32 v17, v17, v206
    v_add_f32 v18, v18, v212
    v_add_f32 v19, v19, v214
    v_pk_add_f32 v[16:17], v[16:17], v[18:19]
    v_mov_b32 v18, v16
    v_mov_b32 v19, v17
    s_nop 1
    v_permlane16_swap_b32 v18, v16
    v_permlane16_swap_b32 v19, v17
    v_pk_add_f32 v[16:17], v[18:19], v[16:17]
    v_mov_b32 v18, v16
    v_mov_b32 v19, v17
    s_nop 1
    v_permlane32_swap_b32 v18, v16
    v_permlane32_swap_b32 v19, v17
    v_pk_add_f32 v[16:17], v[18:19], v[16:17]
    v_cvt_pk_bf16_f32 v28, v16, v17
    v_lshlrev_b32 v16, 16, v28
    v_and_b32 v17, 0xffff0000, v28
    v_pk_mul_f32 v[16:17], v[16:17], v[24:25]
    v_cvt_pk_bf16_f32 v28, v16, v17
    v_lshlrev_b32 v16, 16, v28
    v_and_b32 v17, 0xffff0000, v28
    v_pk_add_f32 v[16:17], v[16:17], v[26:27]
    v_cvt_pk_bf16_f32 v20, v16, v17
    buffer_store_dwordx2 v[20:21], v5, s[40:43], s64 offen sc1
    s_branch Ldone_200
Lnr2_226:
    s_cmp_eq_u32 s69, 1
    s_cbranch_scc0 Ldone_200
    s_mul_i32 s62, s33, 2560
    s_and_b32 s63, s68, 3
    s_mul_i32 s63, s63, 10240
    s_add_u32 s62, s62, s63
    s_add_u32 s62, s62, 983040
    v_lshlrev_b32 v4, 3, v1
    s_lshl_b32 s63, s33, 10
    s_add_u32 s63, s63, 0
    v_lshlrev_b32 v10, 4, v1
    v_add_u32 v11, s63, v10
    v_lshrrev_b32 v6, 4, v1
    v_mul_u32_u24 v6, 6144, v6
    v_and_b32 v7, 15, v1
    v_lshl_add_u32 v12, v7, 3, v6
    s_lshl_b32 s64, s68, 7
    s_add_u32 s64, s64, 196608
    v_mov_b32 v33, s32
Lw_235:
    ds_read_b32 v8, v2 offset:128
    s_waitcnt lgkmcnt(0)
    v_readfirstlane_b32 s90, v8
    s_nop 0
    s_cmp_ge_u32 s90, 1
    s_cbranch_scc1 Lwd_236
    s_sleep 2
    s_sub_u32 s96, s96, 1
    s_cbranch_scc1 Labort
    s_branch Lw_235
Lwd_236:
    s_mov_b32 s58, s62
    s_cmp_eq_u32 s69, 1
    s_cbranch_scc0 Lhc_237
    s_mov_b32 s36, s18
    s_and_b32 s37, s19, 0xffff
    s_mov_b32 s38, 1966080
    s_mov_b32 s39, 0x20000
    s_mul_i32 s62, s33, 160
    v_lshrrev_b32 v6, 4, v1
    v_lshlrev_b32 v6, 3, v6
    v_add_u32 v6, s62, v6
    v_mul_u32_u24 v6, 3072, v6
    v_and_b32 v7, 15, v1
    v_lshl_add_u32 v6, v7, 2, v6
    s_lshl_b32 s62, s68, 6
    v_add_u32 v6, s62, v6
    s_mov_b32 s62, 0
    buffer_load_dword v92, v6, s[36:39], s62 offen nt
    s_mov_b32 s62, 3072
    buffer_load_dword v93, v6, s[36:39], s62 offen nt
    s_mov_b32 s62, 6144
    buffer_load_dword v94, v6, s[36:39], s62 offen nt
    s_mov_b32 s62, 9216
    buffer_load_dword v95, v6, s[36:39], s62 offen nt
    s_mov_b32 s62, 12288
    buffer_load_dword v96, v6, s[36:39], s62 offen nt
    s_mov_b32 s62, 15360
    buffer_load_dword v97, v6, s[36:39], s62 offen nt
    s_mov_b32 s62, 18432
    buffer_load_dword v98, v6, s[36:39], s62 offen nt
    s_mov_b32 s62, 21504
    buffer_load_dword v99, v6, s[36:39], s62 offen nt
    s_mov_b32 s62, 98304
    buffer_load_dword v100, v6, s[36:39], s62 offen nt
    s_mov_b32 s62, 101376
    buffer_load_dword v101, v6, s[36:39], s62 offen nt
    s_mov_b32 s62, 104448
    buffer_load_dword v102, v6, s[36:39], s62 offen nt
    s_mov_b32 s62, 107520
    buffer_load_dword v103, v6, s[36:39], s62 offen nt
    s_mov_b32 s62, 110592
    buffer_load_dword v104, v6, s[36:39], s62 offen nt
    s_mov_b32 s62, 113664
    buffer_load_dword v105, v6, s[36:39], s62 offen nt
    s_mov_b32 s62, 116736
    buffer_load_dword v106, v6, s[36:39], s62 offen nt
    s_mov_b32 s62, 119808
    buffer_load_dword v107, v6, s[36:39], s62 offen nt
    s_mov_b32 s62, 196608
    buffer_load_dword v108, v6, s[36:39], s62 offen nt
    s_mov_b32 s62, 199680
    buffer_load_dword v109, v6, s[36:39], s62 offen nt
    s_mov_b32 s62, 202752
    buffer_load_dword v110, v6, s[36:39], s62 offen nt
    s_mov_b32 s62, 205824
    buffer_load_dword v111, v6, s[36:39], s62 offen nt
    s_mov_b32 s62, 208896
    buffer_load_dword v112, v6, s[36:39], s62 offen nt
    s_mov_b32 s62, 211968
    buffer_load_dword v113, v6, s[36:39], s62 offen nt
    s_mov_b32 s62, 215040
    buffer_load_dword v114, v6, s[36:39], s62 offen nt
    s_mov_b32 s62, 218112
    buffer_load_dword v115, v6, s[36:39], s62 offen nt
    s_mov_b32 s62, 294912
    buffer_load_dword v116, v6, s[36:39], s62 offen nt
    s_mov_b32 s62, 297984
    buffer_load_dword v117, v6, s[36:39], s62 offen nt
    s_mov_b32 s62, 301056
    buffer_load_dword v118, v6, s[36:39], s62 offen nt
    s_mov_b32 s62, 304128
    buffer_load_dword v119, v6, s[36:39], s62 offen nt
    s_mov_b32 s62, 307200
    buffer_load_dword v120, v6, s[36:39], s62 offen nt
    s_mov_b32 s62, 310272
    buffer_load_dword v121, v6, s[36:39], s62 offen nt
    s_mov_b32 s62, 313344
    buffer_load_dword v122, v6, s[36:39], s62 offen nt
    s_mov_b32 s62, 316416
    buffer_load_dword v123, v6, s[36:39], s62 offen nt
    s_mov_b32 s62, 393216
    buffer_load_dword v124, v6, s[36:39], s62 offen nt
    s_mov_b32 s62, 396288
    buffer_load_dword v125, v6, s[36:39], s62 offen nt
    s_mov_b32 s62, 399360
    buffer_load_dword v126, v6, s[36:39], s62 offen nt
    s_mov_b32 s62, 402432
    buffer_load_dword v127, v6, s[36:39], s62 offen nt
    s_mov_b32 s62, 405504
    buffer_load_dword v128, v6, s[36:39], s62 offen nt
    s_mov_b32 s62, 408576
    buffer_load_dword v129, v6, s[36:39], s62 offen nt
    s_mov_b32 s62, 411648
    buffer_load_dword v130, v6, s[36:39], s62 offen nt
    s_mov_b32 s62, 414720
    buffer_load_dword v131, v6, s[36:39], s62 offen nt
    s_waitcnt vmcnt(0)
    v_perm_b32 v84, v93, v92, s97
    v_perm_b32 v85, v95, v94, s97
    v_perm_b32 v86, v97, v96, s97
    v_perm_b32 v87, v99, v98, s97
    v_perm_b32 v88, v93, v92, s98
    v_perm_b32 v89, v95, v94, s98
    v_perm_b32 v90, v97, v96, s98
    v_perm_b32 v91, v99, v98, s98
    v_perm_b32 v92, v101, v100, s97
    v_perm_b32 v93, v103, v102, s97
    v_perm_b32 v94, v105, v104, s97
    v_perm_b32 v95, v107, v106, s97
    v_perm_b32 v96, v101, v100, s98
    v_perm_b32 v97, v103, v102, s98
    v_perm_b32 v98, v105, v104, s98
    v_perm_b32 v99, v107, v106, s98
    v_perm_b32 v100, v109, v108, s97
    v_perm_b32 v101, v111, v110, s97
    v_perm_b32 v102, v113, v112, s97
    v_perm_b32 v103, v115, v114, s97
    v_perm_b32 v104, v109, v108, s98
    v_perm_b32 v105, v111, v110, s98
    v_perm_b32 v106, v113, v112, s98
    v_perm_b32 v107, v115, v114, s98
    v_perm_b32 v108, v117, v116, s97
    v_perm_b32 v109, v119, v118, s97
    v_perm_b32 v110, v121, v120, s97
    v_perm_b32 v111, v123, v122, s97
    v_perm_b32 v112, v117, v116, s98
    v_perm_b32 v113, v119, v118, s98
    v_perm_b32 v114, v121, v120, s98
    v_perm_b32 v115, v123, v122, s98
    v_perm_b32 v116, v125, v124, s97
    v_perm_b32 v117, v127, v126, s97
    v_perm_b32 v118, v129, v128, s97
    v_perm_b32 v119, v131, v130, s97
    v_perm_b32 v120, v125, v124, s98
    v_perm_b32 v121, v127, v126, s98
    v_perm_b32 v122, v129, v128, s98
    v_perm_b32 v123, v131, v130, s98
Lhc_237:
    s_cmp_eq_u32 s69, 2
    s_cbranch_scc0 Lhd_238
    s_mov_b32 s36, s20
    s_and_b32 s37, s21, 0xffff
    s_mov_b32 s38, 1966080
    s_mov_b32 s39, 0x20000
    s_mul_i32 s62, s33, 384
    v_lshrrev_b32 v6, 4, v1
    v_lshlrev_b32 v6, 3, v6
    v_add_u32 v6, s62, v6
    v_mul_u32_u24 v6, 1280, v6
    v_and_b32 v7, 15, v1
    v_lshl_add_u32 v6, v7, 2, v6
    s_lshl_b32 s62, s68, 6
    v_add_u32 v6, s62, v6
    s_mov_b32 s62, 245760
    buffer_load_dword v156, v6, s[36:39], s62 offen nt
    s_mov_b32 s62, 247040
    buffer_load_dword v157, v6, s[36:39], s62 offen nt
    s_mov_b32 s62, 248320
    buffer_load_dword v158, v6, s[36:39], s62 offen nt
    s_mov_b32 s62, 249600
    buffer_load_dword v159, v6, s[36:39], s62 offen nt
    s_mov_b32 s62, 250880
    buffer_load_dword v160, v6, s[36:39], s62 offen nt
    s_mov_b32 s62, 252160
    buffer_load_dword v161, v6, s[36:39], s62 offen nt
    s_mov_b32 s62, 253440
    buffer_load_dword v162, v6, s[36:39], s62 offen nt
    s_mov_b32 s62, 254720
    buffer_load_dword v163, v6, s[36:39], s62 offen nt
    s_mov_b32 s62, 286720
    buffer_load_dword v164, v6, s[36:39], s62 offen nt
    s_mov_b32 s62, 288000
    buffer_load_dword v165, v6, s[36:39], s62 offen nt
    s_mov_b32 s62, 289280
    buffer_load_dword v166, v6, s[36:39], s62 offen nt
    s_mov_b32 s62, 290560
    buffer_load_dword v167, v6, s[36:39], s62 offen nt
    s_mov_b32 s62, 291840
    buffer_load_dword v168, v6, s[36:39], s62 offen nt
    s_mov_b32 s62, 293120
    buffer_load_dword v169, v6, s[36:39], s62 offen nt
    s_mov_b32 s62, 294400
    buffer_load_dword v170, v6, s[36:39], s62 offen nt
    s_mov_b32 s62, 295680
    buffer_load_dword v171, v6, s[36:39], s62 offen nt
    s_mov_b32 s62, 327680
    buffer_load_dword v172, v6, s[36:39], s62 offen nt
    s_mov_b32 s62, 328960
    buffer_load_dword v173, v6, s[36:39], s62 offen nt
    s_mov_b32 s62, 330240
    buffer_load_dword v174, v6, s[36:39], s62 offen nt
    s_mov_b32 s62, 331520
    buffer_load_dword v175, v6, s[36:39], s62 offen nt
    s_mov_b32 s62, 332800
    buffer_load_dword v176, v6, s[36:39], s62 offen nt
    s_mov_b32 s62, 334080
    buffer_load_dword v177, v6, s[36:39], s62 offen nt
    s_mov_b32 s62, 335360
    buffer_load_dword v178, v6, s[36:39], s62 offen nt
    s_mov_b32 s62, 336640
    buffer_load_dword v179, v6, s[36:39], s62 offen nt
    s_mov_b32 s62, 368640
    buffer_load_dword v180, v6, s[36:39], s62 offen nt
    s_mov_b32 s62, 369920
    buffer_load_dword v181, v6, s[36:39], s62 offen nt
    s_mov_b32 s62, 371200
    buffer_load_dword v182, v6, s[36:39], s62 offen nt
    s_mov_b32 s62, 372480
    buffer_load_dword v183, v6, s[36:39], s62 offen nt
    s_mov_b32 s62, 373760
    buffer_load_dword v184, v6, s[36:39], s62 offen nt
    s_mov_b32 s62, 375040
    buffer_load_dword v185, v6, s[36:39], s62 offen nt
    s_mov_b32 s62, 376320
    buffer_load_dword v186, v6, s[36:39], s62 offen nt
    s_mov_b32 s62, 377600
    buffer_load_dword v187, v6, s[36:39], s62 offen nt
    s_mov_b32 s62, 409600
    buffer_load_dword v188, v6, s[36:39], s62 offen nt
    s_mov_b32 s62, 410880
    buffer_load_dword v189, v6, s[36:39], s62 offen nt
    s_mov_b32 s62, 412160
    buffer_load_dword v190, v6, s[36:39], s62 offen nt
    s_mov_b32 s62, 413440
    buffer_load_dword v191, v6, s[36:39], s62 offen nt
    s_mov_b32 s62, 414720
    buffer_load_dword v192, v6, s[36:39], s62 offen nt
    s_mov_b32 s62, 416000
    buffer_load_dword v193, v6, s[36:39], s62 offen nt
    s_mov_b32 s62, 417280
    buffer_load_dword v194, v6, s[36:39], s62 offen nt
    s_mov_b32 s62, 418560
    buffer_load_dword v195, v6, s[36:39], s62 offen nt
    s_mov_b32 s62, 450560
    buffer_load_dword v196, v6, s[36:39], s62 offen nt
    s_mov_b32 s62, 451840
    buffer_load_dword v197, v6, s[36:39], s62 offen nt
    s_mov_b32 s62, 453120
    buffer_load_dword v198, v6, s[36:39], s62 offen nt
    s_mov_b32 s62, 454400
    buffer_load_dword v199, v6, s[36:39], s62 offen nt
    s_mov_b32 s62, 455680
    buffer_load_dword v200, v6, s[36:39], s62 offen nt
    s_mov_b32 s62, 456960
    buffer_load_dword v201, v6, s[36:39], s62 offen nt
    s_mov_b32 s62, 458240
    buffer_load_dword v202, v6, s[36:39], s62 offen nt
    s_mov_b32 s62, 459520
    buffer_load_dword v203, v6, s[36:39], s62 offen nt
    s_waitcnt vmcnt(0)
    v_perm_b32 v148, v157, v156, s97
    v_perm_b32 v149, v159, v158, s97
    v_perm_b32 v150, v161, v160, s97
    v_perm_b32 v151, v163, v162, s97
    v_perm_b32 v152, v157, v156, s98
    v_perm_b32 v153, v159, v158, s98
    v_perm_b32 v154, v161, v160, s98
    v_perm_b32 v155, v163, v162, s98
    v_perm_b32 v156, v165, v164, s97
    v_perm_b32 v157, v167, v166, s97
    v_perm_b32 v158, v169, v168, s97
    v_perm_b32 v159, v171, v170, s97
    v_perm_b32 v160, v165, v164, s98
    v_perm_b32 v161, v167, v166, s98
    v_perm_b32 v162, v169, v168, s98
    v_perm_b32 v163, v171, v170, s98
    v_perm_b32 v164, v173, v172, s97
    v_perm_b32 v165, v175, v174, s97
    v_perm_b32 v166, v177, v176, s97
    v_perm_b32 v167, v179, v178, s97
    v_perm_b32 v168, v173, v172, s98
    v_perm_b32 v169, v175, v174, s98
    v_perm_b32 v170, v177, v176, s98
    v_perm_b32 v171, v179, v178, s98
    v_perm_b32 v172, v181, v180, s97
    v_perm_b32 v173, v183, v182, s97
    v_perm_b32 v174, v185, v184, s97
    v_perm_b32 v175, v187, v186, s97
    v_perm_b32 v176, v181, v180, s98
    v_perm_b32 v177, v183, v182, s98
    v_perm_b32 v178, v185, v184, s98
    v_perm_b32 v179, v187, v186, s98
    v_perm_b32 v180, v189, v188, s97
    v_perm_b32 v181, v191, v190, s97
    v_perm_b32 v182, v193, v192, s97
    v_perm_b32 v183, v195, v194, s97
    v_perm_b32 v184, v189, v188, s98
    v_perm_b32 v185, v191, v190, s98
    v_perm_b32 v186, v193, v192, s98
    v_perm_b32 v187, v195, v194, s98
    v_perm_b32 v188, v197, v196, s97
    v_perm_b32 v189, v199, v198, s97
    v_perm_b32 v190, v201, v200, s97
    v_perm_b32 v191, v203, v202, s97
    v_perm_b32 v192, v197, v196, s98
    v_perm_b32 v193, v199, v198, s98
    v_perm_b32 v194, v201, v200, s98
    v_perm_b32 v195, v203, v202, s98
Lhd_238:
    s_mov_b32 s62, s58
    s_cmp_eq_u32 s33, 0
    s_cbranch_scc0 Lgate_239
    s_lshl_b32 s63, s68, 13
    s_add_u32 s63, s63, 262144
    v_lshlrev_b32 v6, 8, v1
    s_mov_b32 exec_lo, -1
    s_mov_b32 exec_hi, 0
    s_branch Lpoll_241
Lpollr_242:
    s_sleep 2
    s_sub_u32 s96, s96, 1
    s_cbranch_scc1 Labort
Lpoll_241:
    buffer_load_dwordx2 v[14:15], v6, s[40:43], s63 offen sc1
    s_waitcnt vmcnt(0)
    v_xor_b32 v28, s32, v15
    v_cmp_ne_u32 vcc, 0, v28
    s_nop 1
    s_cbranch_vccnz Lpollr_242
Lpolld_243:
    s_mov_b64 exec, -1
    s_mov_b64 exec, 1
    ds_write_b32 v9, v3 offset:12
    s_mov_b64 exec, -1
Lgate_239:
Lw_244:
    ds_read_b32 v8, v9 offset:12
    s_waitcnt lgkmcnt(0)
    v_readfirstlane_b32 s90, v8
    s_nop 0
    s_cmp_ge_u32 s90, 1
    s_cbranch_scc1 Lwd_245
    s_sleep 1
    s_sub_u32 s96, s96, 1
    s_cbranch_scc1 Labort
    s_branch Lw_244
Lwd_245:
Lngate_240:
    s_branch Lpoll_246
Lpollr_247:
    s_sub_u32 s96, s96, 1
    s_cbranch_scc1 Labort
Lpoll_246:
    buffer_load_dwordx2 v[184:185], v4, s[40:43], s62 offen offset:0 sc1
    buffer_load_dwordx2 v[186:187], v4, s[40:43], s62 offen offset:512 sc1
    buffer_load_dwordx2 v[188:189], v4, s[40:43], s62 offen offset:1024 sc1
    buffer_load_dwordx2 v[190:191], v4, s[40:43], s62 offen offset:1536 sc1
    buffer_load_dwordx2 v[192:193], v4, s[40:43], s62 offen offset:2048 sc1
    s_waitcnt vmcnt(0)
    v_xor_b32 v28, s32, v185
    v_xor_b32 v29, s32, v187
    v_xor_b32 v30, s32, v189
    v_or3_b32 v28, v28, v29, v30
    v_xor_b32 v29, s32, v191
    v_xor_b32 v30, s32, v193
    v_or3_b32 v28, v28, v29, v30
    v_cmp_ne_u32 vcc, 0, v28
    s_nop 1
    s_cbranch_vccnz Lpollr_247
Lpolld_248:
    v_lshlrev_b32 v16, 16, v184
    v_and_b32 v17, 0xffff0000, v184
    v_lshlrev_b32 v18, 16, v186
    v_and_b32 v19, 0xffff0000, v186
    v_lshlrev_b32 v20, 16, v188
    v_and_b32 v21, 0xffff0000, v188
    v_lshlrev_b32 v22, 16, v190
    v_and_b32 v23, 0xffff0000, v190
    v_lshlrev_b32 v24, 16, v192
    v_and_b32 v25, 0xffff0000, v192
    s_nop 0
    v_readfirstlane_b32 s90, v16
    s_nop 0
    s_mov_b32 s91, s90
    v_pk_add_f32 v[204:205], v[16:17], s[90:91] neg_lo:[0,1] neg_hi:[0,1]
    v_pk_add_f32 v[206:207], v[18:19], s[90:91] neg_lo:[0,1] neg_hi:[0,1]
    v_pk_add_f32 v[208:209], v[20:21], s[90:91] neg_lo:[0,1] neg_hi:[0,1]
    v_pk_add_f32 v[210:211], v[22:23], s[90:91] neg_lo:[0,1] neg_hi:[0,1]
    v_pk_add_f32 v[212:213], v[24:25], s[90:91] neg_lo:[0,1] neg_hi:[0,1]
    v_pk_mul_f32 v[30:31], v[204:205], v[204:205]
    v_pk_add_f32 v[28:29], v[204:205], v[206:207]
    v_pk_fma_f32 v[30:31], v[206:207], v[206:207], v[30:31]
    v_pk_add_f32 v[28:29], v[28:29], v[208:209]
    v_pk_fma_f32 v[30:31], v[208:209], v[208:209], v[30:31]
    v_pk_add_f32 v[28:29], v[28:29], v[210:211]
    v_pk_fma_f32 v[30:31], v[210:211], v[210:211], v[30:31]
    v_pk_add_f32 v[28:29], v[28:29], v[212:213]
    v_pk_fma_f32 v[30:31], v[212:213], v[212:213], v[30:31]
    v_add_f32 v28, v28, v29
    v_add_f32 v30, v30, v31
    s_nop 0
    v_add_f32_dpp v28, v28, v28 row_ror:8 row_mask:0xf bank_mask:0xf
    v_add_f32_dpp v30, v30, v30 row_ror:8 row_mask:0xf bank_mask:0xf
    s_nop 0
    v_add_f32_dpp v28, v28, v28 row_ror:4 row_mask:0xf bank_mask:0xf
    v_add_f32_dpp v30, v30, v30 row_ror:4 row_mask:0xf bank_mask:0xf
    s_nop 0
    v_add_f32_dpp v28, v28, v28 row_ror:2 row_mask:0xf bank_mask:0xf
    v_add_f32_dpp v30, v30, v30 row_ror:2 row_mask:0xf bank_mask:0xf
    s_nop 0
    v_add_f32_dpp v28, v28, v28 row_ror:1 row_mask:0xf bank_mask:0xf
    v_add_f32_dpp v30, v30, v30 row_ror:1 row_mask:0xf bank_mask:0xf
    v_mov_b32 v29, v28
    v_mov_b32 v31, v30
    s_nop 1
    v_permlane16_swap_b32 v29, v28
    v_permlane16_swap_b32 v31, v30
    v_add_f32 v28, v29, v28
    v_add_f32 v30, v31, v30
    v_mov_b32 v29, v28
    v_mov_b32 v31, v30
    s_nop 1
    v_permlane32_swap_b32 v29, v28
    v_permlane32_swap_b32 v31, v30
    v_add_f32 v28, v29, v28
    v_add_f32 v30, v31, v30
    v_mul_f32 v28, 0x3acccccd, v28
    v_mul_f32 v30, 0x3acccccd, v30
    v_fma_f32 v30, -v28, v28, v30
    v_add_f32 v28, s90, v28
    v_max_f32 v30, 0, v30
    v_cvt_pk_bf16_f32 v29, v28, v30
    v_lshlrev_b32 v28, 16, v29
    v_and_b32 v30, 0xffff0000, v29
    v_add_f32 v30, 0x3727c5ac, v30
    v_cvt_pk_bf16_f32 v31, v30, v30
    v_lshlrev_b32 v30, 16, v31
    v_sqrt_f32 v30, v30
    v_pk_add_f32 v[16:17], v[16:17], v[28:29] op_sel_hi:[1,0] neg_lo:[0,1] neg_hi:[0,1]
    v_pk_add_f32 v[18:19], v[18:19], v[28:29] op_sel_hi:[1,0] neg_lo:[0,1] neg_hi:[0,1]
    v_pk_add_f32 v[20:21], v[20:21], v[28:29] op_sel_hi:[1,0] neg_lo:[0,1] neg_hi:[0,1]
    v_pk_add_f32 v[22:23], v[22:23], v[28:29] op_sel_hi:[1,0] neg_lo:[0,1] neg_hi:[0,1]
    v_pk_add_f32 v[24:25], v[24:25], v[28:29] op_sel_hi:[1,0] neg_lo:[0,1] neg_hi:[0,1]
    v_cvt_pk_bf16_f32 v31, v30, v30
    v_lshlrev_b32 v30, 16, v31
    v_rcp_f32 v30, v30
    v_cvt_pk_bf16_f32 v204, v16, v17
    v_cvt_pk_bf16_f32 v205, v18, v19
    v_cvt_pk_bf16_f32 v206, v20, v21
    v_cvt_pk_bf16_f32 v207, v22, v23
    v_cvt_pk_bf16_f32 v208, v24, v25
    v_lshlrev_b32 v16, 16, v204
    v_and_b32 v17, 0xffff0000, v204
    v_lshlrev_b32 v18, 16, v205
    v_and_b32 v19, 0xffff0000, v205
    v_lshlrev_b32 v20, 16, v206
    v_and_b32 v21, 0xffff0000, v206
    v_lshlrev_b32 v22, 16, v207
    v_and_b32 v23, 0xffff0000, v207
    v_lshlrev_b32 v24, 16, v208
    v_and_b32 v25, 0xffff0000, v208
    v_pk_mul_f32 v[16:17], v[16:17], v[30:31] op_sel_hi:[1,0]
    v_pk_mul_f32 v[18:19], v[18:19], v[30:31] op_sel_hi:[1,0]
    v_pk_mul_f32 v[20:21], v[20:21], v[30:31] op_sel_hi:[1,0]
    v_pk_mul_f32 v[22:23], v[22:23], v[30:31] op_sel_hi:[1,0]
    v_pk_mul_f32 v[24:25], v[24:25], v[30:31] op_sel_hi:[1,0]
    v_cvt_pk_bf16_f32 v204, v16, v17
    v_cvt_pk_bf16_f32 v205, v18, v19
    v_cvt_pk_bf16_f32 v206, v20, v21
    v_cvt_pk_bf16_f32 v207, v22, v23
    v_cvt_pk_bf16_f32 v208, v24, v25
    v_lshlrev_b32 v16, 16, v204
    v_and_b32 v17, 0xffff0000, v204
    v_lshlrev_b32 v18, 16, v205
    v_and_b32 v19, 0xffff0000, v205
    v_lshlrev_b32 v20, 16, v206
    v_and_b32 v21, 0xffff0000, v206
    v_lshlrev_b32 v22, 16, v207
    v_and_b32 v23, 0xffff0000, v207
    v_lshlrev_b32 v24, 16, v208
    v_and_b32 v25, 0xffff0000, v208
    v_pk_mul_f32 v[16:17], v[16:17], v[140:141]
    v_pk_mul_f32 v[18:19], v[18:19], v[142:143]
    v_pk_mul_f32 v[20:21], v[20:21], v[144:145]
    v_pk_mul_f32 v[22:23], v[22:23], v[146:147]
    v_pk_mul_f32 v[24:25], v[24:25], v[148:149]
    v_cvt_pk_bf16_f32 v204, v16, v17
    v_cvt_pk_bf16_f32 v205, v18, v19
    v_cvt_pk_bf16_f32 v206, v20, v21
    v_cvt_pk_bf16_f32 v207, v22, v23
    v_cvt_pk_bf16_f32 v208, v24, v25
    v_lshlrev_b32 v16, 16, v204
    v_and_b32 v17, 0xffff0000, v204
    v_lshlrev_b32 v18, 16, v205
    v_and_b32 v19, 0xffff0000, v205
    v_lshlrev_b32 v20, 16, v206
    v_and_b32 v21, 0xffff0000, v206
    v_lshlrev_b32 v22, 16, v207
    v_and_b32 v23, 0xffff0000, v207
    v_lshlrev_b32 v24, 16, v208
    v_and_b32 v25, 0xffff0000, v208
    v_pk_add_f32 v[16:17], v[16:17], v[150:151]
    v_pk_add_f32 v[18:19], v[18:19], v[152:153]
    v_pk_add_f32 v[20:21], v[20:21], v[154:155]
    v_pk_add_f32 v[22:23], v[22:23], v[156:157]
    v_pk_add_f32 v[24:25], v[24:25], v[158:159]
    v_cvt_pk_bf16_f32 v204, v16, v17
    ds_write_b32 v26, v204 offset:0
    v_cvt_pk_bf16_f32 v205, v18, v19
    ds_write_b32 v26, v205 offset:256
    v_cvt_pk_bf16_f32 v206, v20, v21
    ds_write_b32 v26, v206 offset:512
    v_cvt_pk_bf16_f32 v207, v22, v23
    ds_write_b32 v26, v207 offset:768
    v_cvt_pk_bf16_f32 v208, v24, v25
    ds_write_b32 v26, v208 offset:1024
    s_waitcnt lgkmcnt(0)
    s_barrier
    s_waitcnt vmcnt(0)
    ds_read_b128 v[184:187], v5 offset:0
    ds_read_b128 v[188:191], v5 offset:64
    ds_read_b128 v[192:195], v5 offset:128
    ds_read_b128 v[196:199], v5 offset:192
    ds_read_b128 v[200:203], v5 offset:256
    s_waitcnt lgkmcnt(4)
    v_mfma_f32_16x16x32_bf16 v[216:219], v[184:187], v[36:39], 0
    v_mfma_f32_16x16x32_bf16 v[220:223], v[184:187], v[40:43], 0
    v_mfma_f32_16x16x32_bf16 v[224:227], v[184:187], v[84:87], 0
    v_mfma_f32_16x16x32_bf16 v[228:231], v[184:187], v[88:91], 0
    s_waitcnt lgkmcnt(3)
    v_mfma_f32_16x16x32_bf16 v[216:219], v[188:191], v[44:47], v[216:219]
    v_mfma_f32_16x16x32_bf16 v[220:223], v[188:191], v[48:51], v[220:223]
    v_mfma_f32_16x16x32_bf16 v[224:227], v[188:191], v[92:95], v[224:227]
    v_mfma_f32_16x16x32_bf16 v[228:231], v[188:191], v[96:99], v[228:231]
    s_waitcnt lgkmcnt(2)
    v_mfma_f32_16x16x32_bf16 v[216:219], v[192:195], v[52:55], v[216:219]
    v_mfma_f32_16x16x32_bf16 v[220:223], v[192:195], v[56:59], v[220:223]
    v_mfma_f32_16x16x32_bf16 v[224:227], v[192:195], v[100:103], v[224:227]
    v_mfma_f32_16x16x32_bf16 v[228:231], v[192:195], v[104:107], v[228:231]
    s_waitcnt lgkmcnt(1)
    v_mfma_f32_16x16x32_bf16 v[216:219], v[196:199], v[60:63], v[216:219]
    v_mfma_f32_16x16x32_bf16 v[220:223], v[196:199], v[64:67], v[220:223]
    v_mfma_f32_16x16x32_bf16 v[224:227], v[196:199], v[108:111], v[224:227]
    v_mfma_f32_16x16x32_bf16 v[228:231], v[196:199], v[112:115], v[228:231]
    s_waitcnt lgkmcnt(0)
    v_mfma_f32_16x16x32_bf16 v[216:219], v[200:203], v[68:71], v[216:219]
    v_mfma_f32_16x16x32_bf16 v[220:223], v[200:203], v[72:75], v[220:223]
    v_mfma_f32_16x16x32_bf16 v[224:227], v[200:203], v[116:119], v[224:227]
    v_mfma_f32_16x16x32_bf16 v[228:231], v[200:203], v[120:123], v[228:231]
    s_nop 5
    v_mov_b32 v16, v216
    v_mov_b32 v17, v220
    v_mov_b32 v18, v224
    v_mov_b32 v19, v228
    ds_write_b128 v11, v[16:19]
    s_waitcnt lgkmcnt(0)
    s_barrier
    s_cmp_eq_u32 s33, 0
    s_cbranch_scc0 Ldone_200
    ds_read_b128 v[184:187], v10 offset:0
    ds_read_b128 v[188:191], v10 offset:1024
    ds_read_b128 v[192:195], v10 offset:2048
    ds_read_b128 v[196:199], v10 offset:3072
    s_waitcnt lgkmcnt(2)
    v_pk_add_f32 v[184:185], v[184:185], v[188:189]
    v_pk_add_f32 v[186:187], v[186:187], v[190:191]
    s_waitcnt lgkmcnt(0)
    v_pk_add_f32 v[192:193], v[192:193], v[196:197]
    v_pk_add_f32 v[194:195], v[194:195], v[198:199]
    v_pk_add_f32 v[184:185], v[184:185], v[192:193]
    v_pk_add_f32 v[186:187], v[186:187], v[194:195]
    v_cvt_pk_bf16_f32 v28, v184, v185
    v_cvt_pk_bf16_f32 v29, v186, v187
    v_lshlrev_b32 v184, 16, v28
    v_and_b32 v185, 0xffff0000, v28
    v_lshlrev_b32 v186, 16, v29
    v_and_b32 v187, 0xffff0000, v29
    v_pk_mul_f32 v[184:185], v[184:185], v[186:187]
    v_cvt_pk_bf16_f32 v32, v184, v185
    buffer_store_dwordx2 v[32:33], v12, s[40:43], s64 offen sc1
Ldone_200:
    s_waitcnt vmcnt(0)
    s_endpgm
Labort:
    s_mov_b64 exec, 1
    v_mov_b32 v2, 0
    v_mov_b32 v3, 0xdead
    global_store_dword v2, v3, s[28:29]
    s_waitcnt vmcnt(0)
Lexit:
    s_endpgm
.section .rodata,"a"
.p2align 6
.amdhsa_kernel adaLN_cond__gqa_block_cached__glu_gated_bilinear__decode_kernel
  .amdhsa_next_free_vgpr 256
  .amdhsa_next_free_sgpr 102
  .amdhsa_accum_offset 256
  .amdhsa_group_segment_fixed_size 0
  .amdhsa_kernarg_size 112
  .amdhsa_user_sgpr_count 2
  .amdhsa_user_sgpr_kernarg_segment_ptr 1
  .amdhsa_system_sgpr_workgroup_id_x 1
  .amdhsa_float_denorm_mode_32 3
.end_amdhsa_kernel
```
